```python
import torch

def _softmax(x, axis=-1):
    return torch.softmax(x, dim=axis)
def _gelu(x):
    return torch.nn.functional.gelu(x, approximate="tanh")
def _silu(x):
    return torch.nn.functional.silu(x)
def _sigmoid(x):
    return torch.sigmoid(x)
def _layernorm(x, axis=-1, eps=1e-5):
    m = x.mean(dim=axis, keepdim=True)
    v = x.var(dim=axis, keepdim=True, unbiased=False)
    return (x - m) / torch.sqrt(v + eps)
def _scatter_add(tgt, idx, src, axis=0):
    return tgt.clone().index_add_(axis, idx, src)
def _segment_sum(src, seg, n):
    out = torch.zeros((n,) + src.shape[1:], dtype=src.dtype)
    return out.index_add_(0, seg, src)
def _pad(x, pw):
    flat = tuple(v for pair in reversed(pw) for v in pair)
    return torch.nn.functional.pad(x, flat)

kernel_name = 'parallel_sum__compressed_kv_cla__glu_gated_glu__decode'

def setup_inputs():

    _w = (lambda a: (lambda t: t.to(torch.bfloat16) if t.is_floating_point() else t)(torch.as_tensor(a)))
    def _A_setup():
        B, H, Sq, Sk, D, M = 1, 32, 1, 8192, 128, 576
        Dc = 4 * D
        return {
            "x": _w((lambda *s: torch.randn(*s, dtype=torch.bfloat16) * 0.05)(B, Sq, M)),
            "c_kv": _w((lambda *s: torch.randn(*s, dtype=torch.bfloat16) * 1.6)(B, Sk, Dc)),
            "w_q": _w((lambda *s: torch.randn(*s, dtype=torch.bfloat16) * 3.2)(M, H, D) * (M ** -0.5)),
            "w_uk": _w((lambda *s: torch.randn(*s, dtype=torch.bfloat16) * 3.2)(Dc, H, D) * (Dc ** -0.5)),
            "w_uv": _w((lambda *s: torch.randn(*s, dtype=torch.bfloat16) * 1.6)(Dc, H, D) * (Dc ** -0.5)),
            "w_o": _w((lambda *s: torch.randn(*s, dtype=torch.bfloat16) * 1.6)(H, D, M) * ((H * D) ** -0.5)),
        }
    _A_in = _A_setup()

    def _B_setup():
        B, S, D, F = 1, 1, 576, 4608
        return {
            "x": _w((lambda *s: torch.randn(*s, dtype=torch.bfloat16) * 0.05)(B, S, D)),
            "w_gate": _w((lambda *s: torch.randn(*s, dtype=torch.bfloat16) * 0.2)(D, F)),
            "w_up": _w((lambda *s: torch.randn(*s, dtype=torch.bfloat16) * 0.05)(D, F)),
            "w_down": _w((lambda *s: torch.randn(*s, dtype=torch.bfloat16) * 0.05)(F, D)),
        }
    _B_in = _B_setup()

    return {
        "A_x": _A_in["x"],
        "A_c_kv": _A_in["c_kv"],
        "A_w_q": _A_in["w_q"],
        "A_w_uk": _A_in["w_uk"],
        "A_w_uv": _A_in["w_uv"],
        "A_w_o": _A_in["w_o"],
        "B_x": _B_in["x"],
        "B_w_gate": _B_in["w_gate"],
        "B_w_up": _B_in["w_up"],
        "B_w_down": _B_in["w_down"],
    }

def reference(A_x, A_c_kv, A_w_q, A_w_uk, A_w_uv, A_w_o, B_x, B_w_gate, B_w_up, B_w_down):
    def _A_ref(x, c_kv, w_q, w_uk, w_uv, w_o):
        B, Sq, M = x.shape[0], x.shape[1], x.shape[2]
        Sk = c_kv.shape[1]
        H, D = w_q.shape[1], w_q.shape[2]
        q = torch.einsum("bqm,mhd->bhqd", x, w_q)
        k = torch.einsum("bkc,chd->bhkd", c_kv, w_uk)
        v = torch.einsum("bkc,chd->bhkd", c_kv, w_uv)
        scores = torch.einsum("bhqd,bhkd->bhqk", q, k) * (D ** -0.5)
        off = Sk - Sq
        qi = torch.arange(Sq)[:, None]
        kj = torch.arange(Sk)[None, :]
        cmask = kj <= (qi + off)
        scores = torch.where(cmask[None, None], scores, -1e9)
        p = _softmax(scores, axis=-1)
        ctx = torch.einsum("bhqk,bhkd->bhqd", p, v)
        return torch.einsum("bhqd,hdm->bqm", ctx, w_o)

    def _B_ref(x, w_gate, w_up, w_down):
        g = torch.einsum("bsd,df->bsf", x, w_gate)
        u = torch.einsum("bsd,df->bsf", x, w_up)
        h = _sigmoid(g) * u
        return torch.einsum("bsf,fd->bsd", h, w_down)

    x = A_x
    xn = _layernorm(x, axis=-1)
    return x + _A_ref(xn, A_c_kv, A_w_q, A_w_uk, A_w_uv, A_w_o) + _B_ref(xn, B_w_gate, B_w_up, B_w_down)
```

```asm
; @launch grid=(256,1,1) block=(512,1,1) lds=163840
.amdgcn_target "amdgcn-amd-amdhsa--gfx950"
.text
.globl parallel_sum__compressed_kv_cla__glu_gated_glu__decode_kernel
.p2align 8
.type parallel_sum__compressed_kv_cla__glu_gated_glu__decode_kernel,@function
parallel_sum__compressed_kv_cla__glu_gated_glu__decode_kernel:
    s_cmp_ge_u32 s2, 256
    s_cbranch_scc1 L_exit
    s_load_dwordx16 s[16:31], s[0:1], 0
    s_load_dwordx8 s[32:39], s[0:1], 64
    s_load_dwordx2 s[40:41], s[0:1], 96
    v_lshrrev_b32 v1, 6, v0
    s_and_b32 s4, s2, 7
    v_readfirstlane_b32 s3, v1
    s_bfe_u32 s5, s2, 0x40003
    v_and_b32 v1, 63, v0
    v_and_b32 v2, 15, v1
    v_lshrrev_b32 v3, 4, v1
    s_cmp_eq_u32 s3, 7
    s_cbranch_scc0 L_sk_1
    s_getpc_b64 s[12:13]
L_pc0:
    s_cmp_ge_u32 s2, 128
    s_cselect_b32 s14, L_P-L_pc0, 0
    s_mov_b32 s15, L_P1-L_pc0-16
    s_lshl_b32 s72, s5, 10
    s_add_u32 s14, s14, s72
    v_lshl_add_u32 v4, v1, 4, s14
    v_min_u32 v4, s15, v4
    global_load_dwordx4 v[124:127], v4, s[12:13]
L_sk_1:
    s_lshr_b32 s72, s5, 2
    s_lshl_b32 s73, s4, 2
    s_add_u32 s72, s72, s73
    s_and_b32 s73, s5, 3
    s_and_b32 s98, s5, 1
    s_lshl_b32 s98, s98, 4
    s_lshl_b32 s12, s4, 1
    s_add_u32 s98, s98, s12
    s_lshr_b32 s12, s5, 3
    s_add_u32 s98, s98, s12
    s_bfe_u32 s99, s5, 0x20001
    s_cmp_ge_u32 s2, 128
    s_cbranch_scc1 L_P
    s_and_b32 s12, s3, 1
    s_lshl_b32 s12, s12, 2
    v_add_u32 v5, s12, v3
    v_lshlrev_b32 v5, 1, v5
    v_xor_b32 v5, v5, v2
    v_lshlrev_b32 v5, 4, v5
    v_lshl_add_u32 v7, v3, 13, v5
    v_lshlrev_b32 v11, 2, v1
    s_mul_i32 s74, s73, 144
    s_lshl_b32 s12, s3, 2
    s_add_u32 s74, s74, s12
    s_lshl_b32 s74, s74, 13
    s_lshl_b32 s75, s72, 8
    s_add_u32 s74, s74, s75
    s_lshl_b32 s76, s3, 10
    s_lshl_b32 s78, s72, 11
    s_waitcnt lgkmcnt(0)
    s_load_dword s6, s[40:41], 0
    s_mov_b32 s48, s16
    s_mov_b32 s49, s17
    s_mov_b32 s50, 1152
    s_mov_b32 s51, 0x20000
    s_mov_b32 s52, s20
    s_mov_b32 s53, s21
    s_mov_b32 s54, 4718592
    s_mov_b32 s55, 0x20000
L_S0:
    s_cmp_ge_u32 s3, 4
    s_cbranch_scc1 L_S_hi
    buffer_load_dword v96, v11, s[48:51], 0 offen offset:0
    buffer_load_dword v97, v11, s[48:51], 0 offen offset:256
    buffer_load_dword v98, v11, s[48:51], 0 offen offset:512
    buffer_load_dword v99, v11, s[48:51], 0 offen offset:768
    buffer_load_dword v100, v11, s[48:51], 0 offen offset:1024
    s_add_u32 m0, s76, 1280
    s_add_u32 s12, s74, 0
    buffer_load_dwordx4 v7, s[52:55], s12 offen nt lds
    s_add_u32 m0, s76, 9472
    s_add_u32 s12, s74, 262144
    buffer_load_dwordx4 v7, s[52:55], s12 offen nt lds
    s_add_u32 m0, s76, 17664
    s_add_u32 s12, s74, 524288
    buffer_load_dwordx4 v7, s[52:55], s12 offen nt lds
    s_add_u32 m0, s76, 25856
    s_add_u32 s12, s74, 786432
    buffer_load_dwordx4 v7, s[52:55], s12 offen nt lds
    s_add_u32 m0, s76, 34048
    s_add_u32 s12, s74, 1048576
    buffer_load_dwordx4 v7, s[52:55], s12 offen nt lds
    s_barrier
    s_mov_b32 s44, s40
    s_mov_b32 s45, s41
    s_mov_b32 s46, 7340032
    s_mov_b32 s47, 0x20000
    v_lshrrev_b32 v5, 2, v2
    v_and_b32 v6, 1, v3
    v_lshl_add_u32 v6, v6, 2, v5
    v_lshlrev_b32 v6, 1, v6
    v_bfe_u32 v4, v2, 1, 1
    s_and_b32 s12, s3, 3
    s_lshl_b32 s12, s12, 2
    v_add_u32 v4, s12, v4
    v_xor_b32 v6, v6, v4
    v_lshlrev_b32 v6, 4, v6
    v_lshl_add_u32 v6, v5, 8, v6
    v_lshl_add_u32 v6, v3, 10, v6
    v_and_b32 v5, 1, v2
    v_lshl_add_u32 v8, v5, 3, v6
    v_add_u32 v8, 1280, v8
    s_waitcnt vmcnt(5)
    v_lshlrev_b32 v101, 16, v96
    v_and_b32 v102, 0xffff0000, v96
    v_lshlrev_b32 v103, 16, v97
    v_and_b32 v104, 0xffff0000, v97
    v_lshlrev_b32 v105, 16, v98
    v_and_b32 v106, 0xffff0000, v98
    v_lshlrev_b32 v107, 16, v99
    v_and_b32 v108, 0xffff0000, v99
    v_lshlrev_b32 v109, 16, v100
    v_and_b32 v110, 0xffff0000, v100
    v_add_f32 v27, v101, v102
    v_add_f32 v27, v27, v103
    v_add_f32 v27, v27, v104
    v_add_f32 v27, v27, v105
    v_add_f32 v27, v27, v106
    v_add_f32 v27, v27, v107
    v_add_f32 v27, v27, v108
    v_add_f32 v27, v27, v109
    v_add_f32 v27, v27, v110
    s_nop 1
    v_add_f32_dpp v27, v27, v27 row_ror:8 row_mask:0xf bank_mask:0xf
    s_nop 1
    v_add_f32_dpp v27, v27, v27 row_ror:4 row_mask:0xf bank_mask:0xf
    s_nop 1
    v_add_f32_dpp v27, v27, v27 row_ror:2 row_mask:0xf bank_mask:0xf
    s_nop 1
    v_add_f32_dpp v27, v27, v27 row_ror:1 row_mask:0xf bank_mask:0xf
    v_mov_b32 v5, v27
    s_nop 1
    v_permlane16_swap_b32 v27, v5
    v_add_f32 v27, v27, v5
    v_mov_b32 v5, v27
    s_nop 1
    v_permlane32_swap_b32 v27, v5
    v_add_f32 v27, v27, v5
    v_mul_f32 v27, 0x3ae38e39, v27
    v_sub_f32 v112, v101, v27
    v_sub_f32 v113, v102, v27
    v_sub_f32 v114, v103, v27
    v_sub_f32 v115, v104, v27
    v_sub_f32 v116, v105, v27
    v_sub_f32 v117, v106, v27
    v_sub_f32 v118, v107, v27
    v_sub_f32 v119, v108, v27
    v_sub_f32 v120, v109, v27
    v_sub_f32 v121, v110, v27
    v_cmp_gt_u32 vcc, 32, v1
    s_nop 1
    v_cndmask_b32 v120, 0, v120, vcc
    v_cndmask_b32 v121, 0, v121, vcc
    v_mul_f32 v28, v112, v112
    v_fmac_f32 v28, v113, v113
    v_fmac_f32 v28, v114, v114
    v_fmac_f32 v28, v115, v115
    v_fmac_f32 v28, v116, v116
    v_fmac_f32 v28, v117, v117
    v_fmac_f32 v28, v118, v118
    v_fmac_f32 v28, v119, v119
    v_fmac_f32 v28, v120, v120
    v_fmac_f32 v28, v121, v121
    v_cvt_pk_bf16_f32 v27, v27, v27
    v_and_b32 v27, 0xffff0000, v27
    v_sub_f32 v101, v101, v27
    v_sub_f32 v102, v102, v27
    v_sub_f32 v103, v103, v27
    v_sub_f32 v104, v104, v27
    v_sub_f32 v105, v105, v27
    v_sub_f32 v106, v106, v27
    v_sub_f32 v107, v107, v27
    v_sub_f32 v108, v108, v27
    v_sub_f32 v109, v109, v27
    v_sub_f32 v110, v110, v27
    v_cndmask_b32 v109, 0, v109, vcc
    v_cndmask_b32 v110, 0, v110, vcc
    v_add_f32_dpp v28, v28, v28 row_ror:8 row_mask:0xf bank_mask:0xf
    v_cvt_pk_bf16_f32 v112, v101, v102
    v_lshlrev_b32 v101, 16, v112
    v_and_b32 v102, 0xffff0000, v112
    v_add_f32_dpp v28, v28, v28 row_ror:4 row_mask:0xf bank_mask:0xf
    v_cvt_pk_bf16_f32 v113, v103, v104
    v_lshlrev_b32 v103, 16, v113
    v_and_b32 v104, 0xffff0000, v113
    v_add_f32_dpp v28, v28, v28 row_ror:2 row_mask:0xf bank_mask:0xf
    v_cvt_pk_bf16_f32 v114, v105, v106
    v_lshlrev_b32 v105, 16, v114
    v_and_b32 v106, 0xffff0000, v114
    v_add_f32_dpp v28, v28, v28 row_ror:1 row_mask:0xf bank_mask:0xf
    v_cvt_pk_bf16_f32 v115, v107, v108
    v_lshlrev_b32 v107, 16, v115
    v_and_b32 v108, 0xffff0000, v115
    v_cvt_pk_bf16_f32 v116, v109, v110
    v_lshlrev_b32 v109, 16, v116
    v_and_b32 v110, 0xffff0000, v116
    v_mov_b32 v5, v28
    s_nop 1
    v_permlane16_swap_b32 v28, v5
    v_add_f32 v28, v28, v5
    v_mov_b32 v5, v28
    s_nop 1
    v_permlane32_swap_b32 v28, v5
    v_add_f32 v28, v28, v5
    v_mul_f32 v5, 0x3ae38e39, v28
    v_cvt_pk_bf16_f32 v5, v5, v5
    v_and_b32 v5, 0xffff0000, v5
    v_add_f32 v5, 0x3727c5ac, v5
    v_cvt_pk_bf16_f32 v5, v5, v5
    v_and_b32 v5, 0xffff0000, v5
    v_sqrt_f32 v5, v5
    s_nop 0
    v_cvt_pk_bf16_f32 v5, v5, v5
    v_and_b32 v5, 0xffff0000, v5
    v_rcp_f32 v5, v5
    s_nop 0
    v_mul_f32 v101, v101, v5
    v_mul_f32 v102, v102, v5
    v_mul_f32 v103, v103, v5
    v_mul_f32 v104, v104, v5
    v_mul_f32 v105, v105, v5
    v_mul_f32 v106, v106, v5
    v_mul_f32 v107, v107, v5
    v_mul_f32 v108, v108, v5
    v_mul_f32 v109, v109, v5
    v_mul_f32 v110, v110, v5
    v_cvt_pk_bf16_f32 v96, v101, v102
    v_cvt_pk_bf16_f32 v97, v103, v104
    v_cvt_pk_bf16_f32 v98, v105, v106
    v_cvt_pk_bf16_f32 v99, v107, v108
    v_cvt_pk_bf16_f32 v100, v109, v110
    ds_write_b32 v11, v96 offset:0
    ds_write_b32 v11, v97 offset:256
    ds_write_b32 v11, v98 offset:512
    ds_write_b32 v11, v99 offset:768
    ds_write_b32 v11, v100 offset:1024
    s_waitcnt lgkmcnt(0)
    s_add_u32 s6, s6, 0x9e3779b9
    s_bfe_u32 s8, s6, 0x80000
    s_bfe_u32 s9, s6, 0x80008
    s_bfe_u32 s10, s6, 0x80010
    s_bfe_u32 s11, s6, 0x80018
    v_and_b32 v10, 3, v1
    v_lshlrev_b32 v10, 3, v10
    v_lshrrev_b32 v10, v10, s6
    v_and_b32 v10, 0xff, v10
    s_mov_b32 s7, 0xffffff00
    s_mul_i32 s12, s73, 288
    v_lshl_add_u32 v24, v3, 3, s12
    ds_read_b64 a[0:1], v24 offset:0
    ds_read_b64 a[2:3], v24 offset:32
    ds_read_b64 a[4:5], v24 offset:64
    ds_read_b64 a[6:7], v24 offset:96
    ds_read_b64 a[8:9], v24 offset:128
    ds_read_b64 a[10:11], v24 offset:160
    ds_read_b64 a[12:13], v24 offset:192
    ds_read_b64 a[14:15], v24 offset:224
    ds_read_b64 a[16:17], v24 offset:256
    v_xor_b32 v5, 32, v8
    s_lshl_b32 s12, s73, 9
    s_add_u32 s12, s12, s78
    s_lshl_b32 s13, s3, 7
    s_add_u32 s12, s12, s13
    s_add_u32 s79, s12, 65536
    s_waitcnt vmcnt(0)
    s_barrier
    ds_read_b64_tr_b16 a[20:21], v8 offset:0
    ds_read_b64_tr_b16 a[40:41], v5 offset:0
    ds_read_b64_tr_b16 a[22:23], v8 offset:4096
    ds_read_b64_tr_b16 a[42:43], v5 offset:4096
    ds_read_b64_tr_b16 a[24:25], v8 offset:8192
    ds_read_b64_tr_b16 a[44:45], v5 offset:8192
    ds_read_b64_tr_b16 a[26:27], v8 offset:12288
    ds_read_b64_tr_b16 a[46:47], v5 offset:12288
    ds_read_b64_tr_b16 a[28:29], v8 offset:16384
    ds_read_b64_tr_b16 a[48:49], v5 offset:16384
    ds_read_b64_tr_b16 a[30:31], v8 offset:20480
    ds_read_b64_tr_b16 a[50:51], v5 offset:20480
    ds_read_b64_tr_b16 a[32:33], v8 offset:24576
    ds_read_b64_tr_b16 a[52:53], v5 offset:24576
    ds_read_b64_tr_b16 a[34:35], v8 offset:28672
    ds_read_b64_tr_b16 a[54:55], v5 offset:28672
    ds_read_b64_tr_b16 a[36:37], v8 offset:32768
    ds_read_b64_tr_b16 a[56:57], v5 offset:32768
    s_waitcnt lgkmcnt(14)
    v_mfma_f32_16x16x32_bf16 v[52:55], a[0:3], a[20:23], 0
    v_mfma_f32_16x16x32_bf16 v[56:59], a[0:3], a[40:43], 0
    s_waitcnt lgkmcnt(10)
    v_mfma_f32_16x16x32_bf16 v[52:55], a[4:7], a[24:27], v[52:55]
    v_mfma_f32_16x16x32_bf16 v[56:59], a[4:7], a[44:47], v[56:59]
    s_waitcnt lgkmcnt(6)
    v_mfma_f32_16x16x32_bf16 v[52:55], a[8:11], a[28:31], v[52:55]
    v_mfma_f32_16x16x32_bf16 v[56:59], a[8:11], a[48:51], v[56:59]
    s_waitcnt lgkmcnt(2)
    v_mfma_f32_16x16x32_bf16 v[52:55], a[12:15], a[32:35], v[52:55]
    v_mfma_f32_16x16x32_bf16 v[56:59], a[12:15], a[52:55], v[56:59]
    s_waitcnt lgkmcnt(0)
    v_mfma_f32_16x16x16_bf16 v[60:63], a[16:17], a[36:37], 0
    v_mfma_f32_16x16x16_bf16 v[64:67], a[16:17], a[56:57], 0
    s_nop 6
    v_add_f32 v52, v52, v60
    v_add_f32 v56, v56, v64
    s_nop 1
    v_mov_b32_dpp v52, v56 quad_perm:[0,1,2,3] row_mask:0x2 bank_mask:0xf
    v_cvt_pk_bf16_f32 v52, v52, v52
    v_and_or_b32 v52, v52, s7, v10
    s_mov_b32 exec_hi, 0
    s_add_u32 s15, s79, 196608
    buffer_store_dword v52, v11, s[44:47], s15 offen
    buffer_store_dword v52, v11, s[44:47], s79 offen sc1
    s_mov_b64 exec, -1
    v_lshrrev_b32 v5, 3, v1
    v_and_b32 v6, 6, v5
    v_and_b32 v13, 7, v1
    v_xor_b32 v13, v13, v6
    v_lshlrev_b32 v13, 4, v13
    v_mul_u32_u24 v5, 9216, v5
    v_add_u32 v13, v13, v5
    v_lshrrev_b32 v5, 3, v1
    v_and_b32 v6, 6, v5
    v_and_b32 v14, 7, v1
    v_xor_b32 v14, v14, v6
    v_lshlrev_b32 v14, 4, v14
    v_mul_u32_u24 v5, 1152, v5
    v_add_u32 v14, v14, v5
    v_lshrrev_b32 v5, 2, v2
    v_bfe_u32 v4, v2, 1, 1
    v_and_b32 v6, 6, v5
    v_xor_b32 v6, v6, v4
    v_lshlrev_b32 v6, 4, v6
    v_lshl_add_u32 v6, v5, 7, v6
    v_and_b32 v20, 1, v2
    v_lshl_add_u32 v20, v20, 3, v6
    v_add_u32 v20, 4096, v20
    v_and_b32 v6, 1, v3
    v_lshl_add_u32 v5, v6, 2, v5
    v_and_b32 v6, 6, v5
    v_xor_b32 v6, v6, v4
    v_lshlrev_b32 v6, 4, v6
    v_lshl_add_u32 v6, v5, 7, v6
    v_lshrrev_b32 v5, 1, v3
    v_lshl_add_u32 v6, v5, 10, v6
    v_and_b32 v16, 1, v2
    v_lshl_add_u32 v16, v16, 3, v6
    s_mul_i32 s76, s3, 4608
    v_xor_b32 v17, 32, v16
    v_xor_b32 v18, 64, v16
    v_xor_b32 v19, 96, v16
    v_xor_b32 v21, 32, v20
    v_xor_b32 v22, 64, v20
    v_xor_b32 v23, 96, v20
    v_and_b32 v5, 31, v1
    v_min_u32 v5, 17, v5
    v_lshrrev_b32 v6, 5, v1
    v_lshlrev_b32 v30, 4, v5
    v_lshl_add_u32 v31, v6, 3, v30
    v_mul_u32_u24 v6, 4608, v6
    v_add_u32 v30, v30, v6
    v_add_u32 v6, 2160, v30
    v_cmp_lt_u32 vcc, 8, v5
    s_nop 1
    v_cndmask_b32 v30, v30, v6, vcc
    s_mul_i32 s88, s4, 16*4608
    s_mul_i32 s12, s5, 144
    s_add_u32 s88, s88, s12
    s_add_u32 s88, s88, 1048576
    v_add_u32 v31, 162048, v31
    v_lshrrev_b32 v5, 2, v2
    v_lshlrev_b32 v5, 9, v5
    v_and_b32 v6, 1, v2
    v_lshl_add_u32 v5, v6, 6, v5
    v_lshl_add_u32 v32, v3, 4, v5
    s_mov_b32 s60, s30
    s_mov_b32 s61, s31
    s_mov_b32 s62, 5308416
    s_mov_b32 s63, 0x20000
    s_mov_b32 s64, s32
    s_mov_b32 s65, s33
    s_mov_b32 s66, 5308416
    s_mov_b32 s67, 0x20000
    s_mov_b32 s68, s34
    s_mov_b32 s69, s35
    s_mov_b32 s70, 5308416
    s_mov_b32 s71, 0x20000
    s_mov_b32 s92, s26
    s_mov_b32 s93, s27
    s_mov_b32 s94, 4718592
    s_mov_b32 s95, 0x20000
    s_barrier
    s_mul_i32 s74, s5, 36*9216
    s_mul_i32 s12, s4, 1152
    s_add_u32 s74, s74, s12
    s_and_b32 s80, s3, 3
    s_lshr_b32 s81, s3, 2
    s_mul_i32 s82, s81, 41472
    s_add_u32 s82, s82, 107776
    s_mul_i32 s12, s80, 8*9216
    s_add_u32 s12, s12, s74
    s_add_u32 s12, s12, 1024
    s_lshl_b32 s13, s80, 10
    s_add_u32 s13, s13, s82
    s_add_u32 s15, s74, 295936
    s_add_u32 s83, s82, 4096
    s_cmp_lg_u32 s81, 0
    s_cbranch_scc1 L_up9_2
    s_mov_b32 m0, s13
    s_nop 0
    buffer_load_dwordx4 v13, s[60:63], s12 offen nt lds
    s_cmp_eq_u32 s80, 0
    s_cbranch_scc0 L_sk_4
    s_mov_b32 exec_hi, 0
    s_mov_b32 m0, s83
    s_nop 0
    buffer_load_dwordx4 v13, s[60:63], s15 offen nt lds
    s_mov_b64 exec, -1
L_sk_4:
    s_branch L_j9_3
L_up9_2:
    s_mov_b32 m0, s13
    s_nop 0
    buffer_load_dwordx4 v13, s[64:67], s12 offen nt lds
    s_cmp_eq_u32 s80, 0
    s_cbranch_scc0 L_sk_5
    s_mov_b32 exec_hi, 0
    s_mov_b32 m0, s83
    s_nop 0
    buffer_load_dwordx4 v13, s[64:67], s15 offen nt lds
    s_mov_b64 exec, -1
L_sk_5:
L_j9_3:
    s_lshl_b32 s12, s3, 7
    s_add_u32 s74, s74, s12
    s_add_u32 m0, s76, 70912
    s_add_u32 s12, s74, 0
    buffer_load_dwordx4 v13, s[60:63], s12 offen nt lds
    s_add_u32 m0, s76, 71936
    s_add_u32 s12, s74, 73728
    buffer_load_dwordx4 v13, s[60:63], s12 offen nt lds
    s_barrier
    s_branch L_S_gate
L_S_hi:
    s_add_u32 m0, s76, 1280
    s_add_u32 s12, s74, 0
    buffer_load_dwordx4 v7, s[52:55], s12 offen nt lds
    s_add_u32 m0, s76, 9472
    s_add_u32 s12, s74, 262144
    buffer_load_dwordx4 v7, s[52:55], s12 offen nt lds
    s_add_u32 m0, s76, 17664
    s_add_u32 s12, s74, 524288
    buffer_load_dwordx4 v7, s[52:55], s12 offen nt lds
    s_add_u32 m0, s76, 25856
    s_add_u32 s12, s74, 786432
    buffer_load_dwordx4 v7, s[52:55], s12 offen nt lds
    s_mov_b32 s56, s22
    s_mov_b32 s57, s23
    s_mov_b32 s58, 4194304
    s_mov_b32 s59, 0x20000
    s_mov_b32 s44, s40
    s_mov_b32 s45, s41
    s_mov_b32 s46, 7340032
    s_mov_b32 s47, 0x20000
    v_lshlrev_b32 v5, 2, v3
    v_xor_b32 v5, v5, v2
    v_lshlrev_b32 v5, 4, v5
    v_lshl_add_u32 v12, v3, 13, v5
    s_sub_u32 s80, s3, 4
    s_lshl_b32 s74, s73, 7
    s_lshl_b32 s12, s80, 5
    s_add_u32 s74, s74, s12
    s_lshl_b32 s74, s74, 13
    s_add_u32 s74, s74, s75
    s_lshl_b32 s81, s80, 13
    s_barrier
    s_add_u32 m0, s81, 38144
    s_add_u32 s12, s74, 0
    buffer_load_dwordx4 v12, s[56:59], s12 offen  lds
    v_xor_b32 v12, 16, v12
    s_add_u32 m0, s81, 39168
    s_add_u32 s12, s74, 32768
    buffer_load_dwordx4 v12, s[56:59], s12 offen  lds
    v_xor_b32 v12, 48, v12
    s_add_u32 m0, s81, 40192
    s_add_u32 s12, s74, 65536
    buffer_load_dwordx4 v12, s[56:59], s12 offen  lds
    v_xor_b32 v12, 16, v12
    s_add_u32 m0, s81, 41216
    s_add_u32 s12, s74, 98304
    buffer_load_dwordx4 v12, s[56:59], s12 offen  lds
    v_xor_b32 v12, 48, v12
    s_add_u32 m0, s81, 42240
    s_add_u32 s12, s74, 131072
    buffer_load_dwordx4 v12, s[56:59], s12 offen  lds
    v_xor_b32 v12, 16, v12
    s_add_u32 m0, s81, 43264
    s_add_u32 s12, s74, 163840
    buffer_load_dwordx4 v12, s[56:59], s12 offen  lds
    v_xor_b32 v12, 48, v12
    s_add_u32 m0, s81, 44288
    s_add_u32 s12, s74, 196608
    buffer_load_dwordx4 v12, s[56:59], s12 offen  lds
    v_xor_b32 v12, 16, v12
    s_add_u32 m0, s81, 45312
    s_add_u32 s12, s74, 229376
    buffer_load_dwordx4 v12, s[56:59], s12 offen  lds
    s_waitcnt vmcnt(8)
    s_barrier
    v_lshrrev_b32 v5, 3, v1
    v_and_b32 v6, 6, v5
    v_and_b32 v13, 7, v1
    v_xor_b32 v13, v13, v6
    v_lshlrev_b32 v13, 4, v13
    v_mul_u32_u24 v5, 9216, v5
    v_add_u32 v13, v13, v5
    v_lshrrev_b32 v5, 3, v1
    v_and_b32 v6, 6, v5
    v_and_b32 v14, 7, v1
    v_xor_b32 v14, v14, v6
    v_lshlrev_b32 v14, 4, v14
    v_mul_u32_u24 v5, 1152, v5
    v_add_u32 v14, v14, v5
    v_lshrrev_b32 v5, 2, v2
    v_bfe_u32 v4, v2, 1, 1
    v_and_b32 v6, 6, v5
    v_xor_b32 v6, v6, v4
    v_lshlrev_b32 v6, 4, v6
    v_lshl_add_u32 v6, v5, 7, v6
    v_and_b32 v20, 1, v2
    v_lshl_add_u32 v20, v20, 3, v6
    v_add_u32 v20, 4096, v20
    v_and_b32 v6, 1, v3
    v_lshl_add_u32 v5, v6, 2, v5
    v_and_b32 v6, 6, v5
    v_xor_b32 v6, v6, v4
    v_lshlrev_b32 v6, 4, v6
    v_lshl_add_u32 v6, v5, 7, v6
    v_lshrrev_b32 v5, 1, v3
    v_lshl_add_u32 v6, v5, 10, v6
    v_and_b32 v16, 1, v2
    v_lshl_add_u32 v16, v16, 3, v6
    s_mul_i32 s76, s3, 4608
    v_xor_b32 v17, 32, v16
    v_xor_b32 v18, 64, v16
    v_xor_b32 v19, 96, v16
    v_xor_b32 v21, 32, v20
    v_xor_b32 v22, 64, v20
    v_xor_b32 v23, 96, v20
    v_and_b32 v5, 31, v1
    v_min_u32 v5, 17, v5
    v_lshrrev_b32 v6, 5, v1
    v_lshlrev_b32 v30, 4, v5
    v_lshl_add_u32 v31, v6, 3, v30
    v_mul_u32_u24 v6, 4608, v6
    v_add_u32 v30, v30, v6
    v_add_u32 v6, 2160, v30
    v_cmp_lt_u32 vcc, 8, v5
    s_nop 1
    v_cndmask_b32 v30, v30, v6, vcc
    s_mul_i32 s88, s4, 16*4608
    s_mul_i32 s12, s5, 144
    s_add_u32 s88, s88, s12
    s_add_u32 s88, s88, 1048576
    v_add_u32 v31, 162048, v31
    v_lshrrev_b32 v5, 2, v2
    v_lshlrev_b32 v5, 9, v5
    v_and_b32 v6, 1, v2
    v_lshl_add_u32 v5, v6, 6, v5
    v_lshl_add_u32 v32, v3, 4, v5
    s_mov_b32 s60, s30
    s_mov_b32 s61, s31
    s_mov_b32 s62, 5308416
    s_mov_b32 s63, 0x20000
    s_mov_b32 s64, s32
    s_mov_b32 s65, s33
    s_mov_b32 s66, 5308416
    s_mov_b32 s67, 0x20000
    s_mov_b32 s68, s34
    s_mov_b32 s69, s35
    s_mov_b32 s70, 5308416
    s_mov_b32 s71, 0x20000
    s_mov_b32 s92, s26
    s_mov_b32 s93, s27
    s_mov_b32 s94, 4718592
    s_mov_b32 s95, 0x20000
    v_and_b32 v5, 3, v2
    v_lshlrev_b32 v5, 5, v5
    v_lshrrev_b32 v6, 2, v2
    v_lshl_add_u32 v5, v6, 9, v5
    v_lshl_add_u32 v29, v3, 7, v5
    s_add_u32 s85, s78, 65536
    s_add_u32 s84, s78, 262144
    s_waitcnt lgkmcnt(0)
    s_add_u32 s6, s6, 0x9e3779b9
    s_bfe_u32 s8, s6, 0x80000
    s_bfe_u32 s9, s6, 0x80008
    s_bfe_u32 s10, s6, 0x80010
    s_bfe_u32 s11, s6, 0x80018
    v_and_b32 v10, 3, v1
    v_lshlrev_b32 v10, 3, v10
    v_lshrrev_b32 v10, v10, s6
    v_and_b32 v10, 0xff, v10
    s_mov_b32 s7, 0xffffff00
    v_and_b32 v5, 3, v2
    v_xor_b32 v5, v5, v3
    v_lshrrev_b32 v6, 2, v2
    v_lshl_add_u32 v5, v5, 2, v6
    v_lshlrev_b32 v5, 4, v5
    v_lshl_add_u32 v5, v2, 8, v5
    v_add_u32 v5, s81, v5
    s_waitcnt vmcnt(0)
    s_mov_b32 s79, s84
    buffer_load_dwordx4 v[84:87], v29, s[44:47], s79 offen sc1
    buffer_load_dwordx4 v[88:91], v29, s[44:47], s79 offen offset:16 sc1
    ds_read_b128 a[0:3], v5 offset:38144
    ds_read_b128 a[16:19], v5 offset:42240
    v_xor_b32 v5, 16, v5
    ds_read_b128 a[4:7], v5 offset:38144
    ds_read_b128 a[20:23], v5 offset:42240
    v_xor_b32 v5, 48, v5
    ds_read_b128 a[8:11], v5 offset:38144
    ds_read_b128 a[24:27], v5 offset:42240
    v_xor_b32 v5, 16, v5
    ds_read_b128 a[12:15], v5 offset:38144
    ds_read_b128 a[28:31], v5 offset:42240
    s_waitcnt vmcnt(0)
    v_xor_b32 v9, s8, v84
    v_bitop3_b32 v9, v85, s9, v9 bitop3:0xbe
    v_bitop3_b32 v9, v86, s10, v9 bitop3:0xbe
    v_bitop3_b32 v9, v87, s11, v9 bitop3:0xbe
    v_bitop3_b32 v9, v88, s8, v9 bitop3:0xbe
    v_bitop3_b32 v9, v89, s9, v9 bitop3:0xbe
    v_bitop3_b32 v9, v90, s10, v9 bitop3:0xbe
    v_bitop3_b32 v9, v91, s11, v9 bitop3:0xbe
    v_and_b32 v9, 0xff, v9
    v_cmp_ne_u32 vcc, 0, v9
    s_mov_b32 s14, 0
    s_and_b64 exec, exec, vcc
    s_cbranch_scc0 L_got_7
L_poll_6:
    s_bitcmp1_b32 s14, 0
    s_cselect_b32 s79, s85, s84
    s_cmp_lt_u32 s14, 64
    s_cselect_b32 s79, s84, s79
    buffer_load_dwordx4 v[84:87], v29, s[44:47], s79 offen sc1
    buffer_load_dwordx4 v[88:91], v29, s[44:47], s79 offen offset:16 sc1
    s_waitcnt vmcnt(0)
    v_xor_b32 v9, s8, v84
    v_bitop3_b32 v9, v85, s9, v9 bitop3:0xbe
    v_bitop3_b32 v9, v86, s10, v9 bitop3:0xbe
    v_bitop3_b32 v9, v87, s11, v9 bitop3:0xbe
    v_bitop3_b32 v9, v88, s8, v9 bitop3:0xbe
    v_bitop3_b32 v9, v89, s9, v9 bitop3:0xbe
    v_bitop3_b32 v9, v90, s10, v9 bitop3:0xbe
    v_bitop3_b32 v9, v91, s11, v9 bitop3:0xbe
    v_and_b32 v9, 0xff, v9
    v_cmp_ne_u32 vcc, 0, v9
    s_add_u32 s14, s14, 1
    s_cmp_lt_u32 s14, 262144
    s_cbranch_scc0 L_got_7
    s_and_b64 exec, exec, vcc
    s_cbranch_scc1 L_poll_6
L_got_7:
    s_mov_b64 exec, -1
    s_barrier
    s_mov_b32 s15, 0x07060302
    v_perm_b32 v92, v85, v84, s15
    v_perm_b32 v93, v87, v86, s15
    v_perm_b32 v94, v89, v88, s15
    v_perm_b32 v95, v91, v90, s15
    s_waitcnt lgkmcnt(0)
    s_nop 0
    v_mfma_f32_16x16x32_bf16 v[52:55], v[92:95], a[0:3], 0
    v_mfma_f32_16x16x32_bf16 v[56:59], v[92:95], a[4:7], 0
    v_mfma_f32_16x16x32_bf16 v[60:63], v[92:95], a[8:11], 0
    v_mfma_f32_16x16x32_bf16 v[64:67], v[92:95], a[12:15], 0
    v_mfma_f32_16x16x32_bf16 v[68:71], v[92:95], a[16:19], 0
    v_mfma_f32_16x16x32_bf16 v[72:75], v[92:95], a[20:23], 0
    v_mfma_f32_16x16x32_bf16 v[76:79], v[92:95], a[24:27], 0
    v_mfma_f32_16x16x32_bf16 v[80:83], v[92:95], a[28:31], 0
    s_lshl_b32 s12, s73, 9
    s_add_u32 s12, s12, s78
    s_lshl_b32 s13, s80, 7
    s_add_u32 s12, s12, s13
    s_add_u32 s12, s12, 6291456
    v_add_f32 v52, v52, v57
    v_add_f32 v62, v62, v67
    v_add_f32 v52, v52, v62
    v_add_f32 v68, v68, v73
    v_add_f32 v78, v78, v83
    v_add_f32 v68, v68, v78
    s_nop 1
    v_permlane16_swap_b32 v52, v68
    v_add_f32 v52, v52, v68
    v_mov_b32 v5, v52
    s_nop 1
    v_permlane32_swap_b32 v52, v5
    v_add_f32 v52, v52, v5
    v_cvt_pk_bf16_f32 v52, v52, v52
    v_and_or_b32 v52, v52, s7, v10
    s_mov_b32 exec_hi, 0
    buffer_store_dword v52, v11, s[44:47], s12 offen sc1
    s_mov_b64 exec, -1
    s_barrier
L_S_ffn:
    s_mul_i32 s74, s5, 36*9216
    s_mul_i32 s12, s4, 1152
    s_add_u32 s74, s74, s12
    s_and_b32 s80, s3, 3
    s_lshr_b32 s81, s3, 2
    s_mul_i32 s82, s81, 41472
    s_add_u32 s82, s82, 107776
    s_mul_i32 s12, s80, 8*9216
    s_add_u32 s12, s12, s74
    s_add_u32 s12, s12, 1024
    s_lshl_b32 s13, s80, 10
    s_add_u32 s13, s13, s82
    s_add_u32 s15, s74, 295936
    s_add_u32 s83, s82, 4096
    s_cmp_lg_u32 s81, 0
    s_cbranch_scc1 L_up9_8
    s_mov_b32 m0, s13
    s_nop 0
    buffer_load_dwordx4 v13, s[60:63], s12 offen nt lds
    s_cmp_eq_u32 s80, 0
    s_cbranch_scc0 L_sk_10
    s_mov_b32 exec_hi, 0
    s_mov_b32 m0, s83
    s_nop 0
    buffer_load_dwordx4 v13, s[60:63], s15 offen nt lds
    s_mov_b64 exec, -1
L_sk_10:
    s_branch L_j9_9
L_up9_8:
    s_mov_b32 m0, s13
    s_nop 0
    buffer_load_dwordx4 v13, s[64:67], s12 offen nt lds
    s_cmp_eq_u32 s80, 0
    s_cbranch_scc0 L_sk_11
    s_mov_b32 exec_hi, 0
    s_mov_b32 m0, s83
    s_nop 0
    buffer_load_dwordx4 v13, s[64:67], s15 offen nt lds
    s_mov_b64 exec, -1
L_sk_11:
L_j9_9:
    s_lshl_b32 s12, s3, 7
    s_add_u32 s74, s74, s12
    s_add_u32 m0, s76, 70912
    s_add_u32 s12, s74, 0
    buffer_load_dwordx4 v13, s[60:63], s12 offen nt lds
    s_add_u32 m0, s76, 71936
    s_add_u32 s12, s74, 73728
    buffer_load_dwordx4 v13, s[60:63], s12 offen nt lds
L_S_gate:
    s_add_u32 m0, s76, 72960
    s_add_u32 s12, s74, 147456
    buffer_load_dwordx4 v13, s[60:63], s12 offen nt lds
    s_add_u32 m0, s76, 73984
    s_add_u32 s12, s74, 221184
    buffer_load_dwordx4 v13, s[60:63], s12 offen nt lds
    s_add_u32 m0, s76, 75008
    s_add_u32 s12, s74, 294912
    s_mov_b32 exec_hi, 0
    buffer_load_dwordx4 v13, s[60:63], s12 offen nt lds
    s_mov_b64 exec, -1
    s_barrier
    s_add_u32 m0, s76, 112384
    s_add_u32 s12, s74, 0
    buffer_load_dwordx4 v13, s[64:67], s12 offen nt lds
    s_add_u32 m0, s76, 113408
    s_add_u32 s12, s74, 73728
    buffer_load_dwordx4 v13, s[64:67], s12 offen nt lds
    s_add_u32 m0, s76, 114432
    s_add_u32 s12, s74, 147456
    buffer_load_dwordx4 v13, s[64:67], s12 offen nt lds
    s_add_u32 m0, s76, 115456
    s_add_u32 s12, s74, 221184
    buffer_load_dwordx4 v13, s[64:67], s12 offen nt lds
    s_add_u32 m0, s76, 116480
    s_add_u32 s12, s74, 294912
    s_mov_b32 exec_hi, 0
    buffer_load_dwordx4 v13, s[64:67], s12 offen nt lds
    s_mov_b64 exec, -1
    s_barrier
    s_mul_i32 s74, s4, 576
    s_mul_i32 s12, s5, 36
    s_add_u32 s74, s74, s12
    s_mul_i32 s74, s74, 1152
    s_lshl_b32 s75, s98, 7
    s_lshl_b32 s12, s99, 5
    s_add_u32 s75, s75, s12
    s_mul_i32 s75, s75, 1152
    s_lshl_b32 s12, s98, 11
    s_lshl_b32 s13, s99, 7
    s_add_u32 s12, s12, s13
    s_add_u32 s97, s12, 131072
    s_add_u32 s96, s12, 327680
    s_cmp_ge_u32 s3, 4
    s_cbranch_scc1 L_S_load
    s_mul_i32 s12, s5, 72
    v_lshl_add_u32 v25, v3, 3, s12
    v_mov_b32 v26, 1152
    s_add_u32 s13, s12, 64
    v_mov_b32 v5, s13
    v_cmp_gt_u32 vcc, 16, v1
    s_nop 1
    v_cndmask_b32 v26, v26, v5, vcc
    ds_read_b64 v[44:45], v25
    ds_read_b64 v[46:47], v25 offset:32
    ds_read_b64 v[48:49], v26
    s_lshl_b32 s79, s4, 4
    s_add_u32 s79, s79, s5
    s_mul_i32 s79, s79, 4608
    s_add_u32 s79, s79, 1048576
    s_lshl_b32 s83, s3, 8
    s_add_u32 s83, s83, s79
    s_add_u32 s77, s83, 4194304
    s_add_u32 s12, s76, 70912
    v_add_u32 v34, s12, v16
    v_add_u32 v38, s12, v20
    v_add_u32 v35, s12, v17
    v_add_u32 v39, s12, v21
    v_add_u32 v36, s12, v18
    v_add_u32 v40, s12, v22
    v_add_u32 v37, s12, v19
    v_add_u32 v41, s12, v23
    s_waitcnt vmcnt(5)
    s_barrier
    ds_read_b64_tr_b16 a[0:1], v34 offset:0
    ds_read_b64_tr_b16 a[2:3], v34 offset:2048
    ds_read_b64_tr_b16 a[16:17], v38 offset:0
    ds_read_b64_tr_b16 a[4:5], v35 offset:0
    ds_read_b64_tr_b16 a[6:7], v35 offset:2048
    ds_read_b64_tr_b16 a[18:19], v39 offset:0
    ds_read_b64_tr_b16 a[8:9], v36 offset:0
    ds_read_b64_tr_b16 a[10:11], v36 offset:2048
    ds_read_b64_tr_b16 a[20:21], v40 offset:0
    ds_read_b64_tr_b16 a[12:13], v37 offset:0
    ds_read_b64_tr_b16 a[14:15], v37 offset:2048
    ds_read_b64_tr_b16 a[22:23], v41 offset:0
    ds_read_b64_tr_b16 a[24:25], v34 offset:18432
    ds_read_b64_tr_b16 a[26:27], v34 offset:20480
    ds_read_b64_tr_b16 a[40:41], v38 offset:18432
    ds_read_b64_tr_b16 a[28:29], v35 offset:18432
    ds_read_b64_tr_b16 a[30:31], v35 offset:20480
    ds_read_b64_tr_b16 a[42:43], v39 offset:18432
    ds_read_b64_tr_b16 a[32:33], v36 offset:18432
    ds_read_b64_tr_b16 a[34:35], v36 offset:20480
    ds_read_b64_tr_b16 a[44:45], v40 offset:18432
    ds_read_b64_tr_b16 a[36:37], v37 offset:18432
    ds_read_b64_tr_b16 a[38:39], v37 offset:20480
    ds_read_b64_tr_b16 a[46:47], v41 offset:18432
    s_waitcnt lgkmcnt(12)
    v_mfma_f32_16x16x16_bf16 v[52:55], v[48:49], a[16:17], 0
    v_mfma_f32_16x16x16_bf16 v[56:59], v[48:49], a[18:19], 0
    v_mfma_f32_16x16x16_bf16 v[60:63], v[48:49], a[20:21], 0
    v_mfma_f32_16x16x16_bf16 v[64:67], v[48:49], a[22:23], 0
    s_nop 2
    v_mfma_f32_16x16x32_bf16 v[52:55], v[44:47], a[0:3], v[52:55]
    v_mfma_f32_16x16x32_bf16 v[56:59], v[44:47], a[4:7], v[56:59]
    v_mfma_f32_16x16x32_bf16 v[60:63], v[44:47], a[8:11], v[60:63]
    v_mfma_f32_16x16x32_bf16 v[64:67], v[44:47], a[12:15], v[64:67]
    s_waitcnt lgkmcnt(0)
    v_mfma_f32_16x16x16_bf16 v[68:71], v[48:49], a[40:41], 0
    v_mfma_f32_16x16x16_bf16 v[72:75], v[48:49], a[42:43], 0
    v_mfma_f32_16x16x16_bf16 v[76:79], v[48:49], a[44:45], 0
    v_mfma_f32_16x16x16_bf16 v[80:83], v[48:49], a[46:47], 0
    s_nop 2
    v_mfma_f32_16x16x32_bf16 v[68:71], v[44:47], a[24:27], v[68:71]
    v_mfma_f32_16x16x32_bf16 v[72:75], v[44:47], a[28:31], v[72:75]
    v_mfma_f32_16x16x32_bf16 v[76:79], v[44:47], a[32:35], v[76:79]
    v_mfma_f32_16x16x32_bf16 v[80:83], v[44:47], a[36:39], v[80:83]
    v_mov_b32_dpp v52, v56 quad_perm:[0,1,2,3] row_mask:0x2 bank_mask:0xf
    s_nop 1
    v_mov_b32_dpp v52, v60 quad_perm:[0,1,2,3] row_mask:0x4 bank_mask:0xf
    s_nop 1
    v_mov_b32_dpp v52, v64 quad_perm:[0,1,2,3] row_mask:0x8 bank_mask:0xf
    v_and_or_b32 v84, v52, s7, v10
    buffer_store_dword v84, v11, s[44:47], s77 offen offset:0
    v_mov_b32_dpp v68, v72 quad_perm:[0,1,2,3] row_mask:0x2 bank_mask:0xf
    s_nop 1
    v_mov_b32_dpp v68, v76 quad_perm:[0,1,2,3] row_mask:0x4 bank_mask:0xf
    s_nop 1
    v_mov_b32_dpp v68, v80 quad_perm:[0,1,2,3] row_mask:0x8 bank_mask:0xf
    v_and_or_b32 v85, v68, s7, v10
    buffer_store_dword v85, v11, s[44:47], s77 offen offset:1024
    s_cmp_eq_u32 s3, 0
    s_cbranch_scc0 L_sk_12
    s_mov_b32 s12, 107776
    v_add_u32 v34, s12, v16
    v_add_u32 v38, s12, v20
    v_add_u32 v35, s12, v17
    v_add_u32 v39, s12, v21
    v_add_u32 v36, s12, v18
    v_add_u32 v40, s12, v22
    v_add_u32 v37, s12, v19
    v_add_u32 v41, s12, v23
    ds_read_b64_tr_b16 a[0:1], v34 offset:0
    ds_read_b64_tr_b16 a[2:3], v34 offset:2048
    ds_read_b64_tr_b16 a[16:17], v38 offset:0
    ds_read_b64_tr_b16 a[4:5], v35 offset:0
    ds_read_b64_tr_b16 a[6:7], v35 offset:2048
    ds_read_b64_tr_b16 a[18:19], v39 offset:0
    ds_read_b64_tr_b16 a[8:9], v36 offset:0
    ds_read_b64_tr_b16 a[10:11], v36 offset:2048
    ds_read_b64_tr_b16 a[20:21], v40 offset:0
    ds_read_b64_tr_b16 a[12:13], v37 offset:0
    ds_read_b64_tr_b16 a[14:15], v37 offset:2048
    ds_read_b64_tr_b16 a[22:23], v41 offset:0
    s_add_u32 s77, s79, 4194304
    s_waitcnt lgkmcnt(0)
    v_mfma_f32_16x16x16_bf16 v[52:55], v[48:49], a[16:17], 0
    v_mfma_f32_16x16x16_bf16 v[56:59], v[48:49], a[18:19], 0
    v_mfma_f32_16x16x16_bf16 v[60:63], v[48:49], a[20:21], 0
    v_mfma_f32_16x16x16_bf16 v[64:67], v[48:49], a[22:23], 0
    s_nop 2
    v_mfma_f32_16x16x32_bf16 v[52:55], v[44:47], a[0:3], v[52:55]
    v_mfma_f32_16x16x32_bf16 v[56:59], v[44:47], a[4:7], v[56:59]
    v_mfma_f32_16x16x32_bf16 v[60:63], v[44:47], a[8:11], v[60:63]
    v_mfma_f32_16x16x32_bf16 v[64:67], v[44:47], a[12:15], v[64:67]
    s_nop 5
    v_mov_b32_dpp v52, v56 quad_perm:[0,1,2,3] row_mask:0x2 bank_mask:0xf
    s_nop 1
    v_mov_b32_dpp v52, v60 quad_perm:[0,1,2,3] row_mask:0x4 bank_mask:0xf
    s_nop 1
    v_mov_b32_dpp v52, v64 quad_perm:[0,1,2,3] row_mask:0x8 bank_mask:0xf
    v_and_or_b32 v88, v52, s7, v10
    buffer_store_dword v88, v11, s[44:47], s77 offen offset:2048
    s_add_u32 s77, s83, 4194304
    s_add_u32 s12, s76, 70912
    v_add_u32 v34, s12, v16
    v_add_u32 v38, s12, v20
    v_add_u32 v35, s12, v17
    v_add_u32 v39, s12, v21
    v_add_u32 v36, s12, v18
    v_add_u32 v40, s12, v22
    v_add_u32 v37, s12, v19
    v_add_u32 v41, s12, v23
    s_waitcnt vmcnt(3)
L_sk_12:
    s_cmp_lg_u32 s3, 0
    s_cbranch_scc0 L_sk_13
    s_waitcnt vmcnt(2)
L_sk_13:
    s_barrier
    ds_read_b64_tr_b16 a[0:1], v34 offset:41472
    ds_read_b64_tr_b16 a[2:3], v34 offset:43520
    ds_read_b64_tr_b16 a[16:17], v38 offset:41472
    ds_read_b64_tr_b16 a[4:5], v35 offset:41472
    ds_read_b64_tr_b16 a[6:7], v35 offset:43520
    ds_read_b64_tr_b16 a[18:19], v39 offset:41472
    ds_read_b64_tr_b16 a[8:9], v36 offset:41472
    ds_read_b64_tr_b16 a[10:11], v36 offset:43520
    ds_read_b64_tr_b16 a[20:21], v40 offset:41472
    ds_read_b64_tr_b16 a[12:13], v37 offset:41472
    ds_read_b64_tr_b16 a[14:15], v37 offset:43520
    ds_read_b64_tr_b16 a[22:23], v41 offset:41472
    ds_read_b64_tr_b16 a[24:25], v34 offset:59904
    ds_read_b64_tr_b16 a[26:27], v34 offset:61952
    ds_read_b64_tr_b16 a[40:41], v38 offset:59904
    ds_read_b64_tr_b16 a[28:29], v35 offset:59904
    ds_read_b64_tr_b16 a[30:31], v35 offset:61952
    ds_read_b64_tr_b16 a[42:43], v39 offset:59904
    ds_read_b64_tr_b16 a[32:33], v36 offset:59904
    ds_read_b64_tr_b16 a[34:35], v36 offset:61952
    ds_read_b64_tr_b16 a[44:45], v40 offset:59904
    ds_read_b64_tr_b16 a[36:37], v37 offset:59904
    ds_read_b64_tr_b16 a[38:39], v37 offset:61952
    ds_read_b64_tr_b16 a[46:47], v41 offset:59904
    s_waitcnt lgkmcnt(12)
    v_mfma_f32_16x16x16_bf16 v[52:55], v[48:49], a[16:17], 0
    v_mfma_f32_16x16x16_bf16 v[56:59], v[48:49], a[18:19], 0
    v_mfma_f32_16x16x16_bf16 v[60:63], v[48:49], a[20:21], 0
    v_mfma_f32_16x16x16_bf16 v[64:67], v[48:49], a[22:23], 0
    s_nop 2
    v_mfma_f32_16x16x32_bf16 v[52:55], v[44:47], a[0:3], v[52:55]
    v_mfma_f32_16x16x32_bf16 v[56:59], v[44:47], a[4:7], v[56:59]
    v_mfma_f32_16x16x32_bf16 v[60:63], v[44:47], a[8:11], v[60:63]
    v_mfma_f32_16x16x32_bf16 v[64:67], v[44:47], a[12:15], v[64:67]
    s_waitcnt lgkmcnt(0)
    v_mfma_f32_16x16x16_bf16 v[68:71], v[48:49], a[40:41], 0
    v_mfma_f32_16x16x16_bf16 v[72:75], v[48:49], a[42:43], 0
    v_mfma_f32_16x16x16_bf16 v[76:79], v[48:49], a[44:45], 0
    v_mfma_f32_16x16x16_bf16 v[80:83], v[48:49], a[46:47], 0
    s_nop 2
    v_mfma_f32_16x16x32_bf16 v[68:71], v[44:47], a[24:27], v[68:71]
    v_mfma_f32_16x16x32_bf16 v[72:75], v[44:47], a[28:31], v[72:75]
    v_mfma_f32_16x16x32_bf16 v[76:79], v[44:47], a[32:35], v[76:79]
    v_mfma_f32_16x16x32_bf16 v[80:83], v[44:47], a[36:39], v[80:83]
    v_mov_b32_dpp v52, v56 quad_perm:[0,1,2,3] row_mask:0x2 bank_mask:0xf
    s_nop 1
    v_mov_b32_dpp v52, v60 quad_perm:[0,1,2,3] row_mask:0x4 bank_mask:0xf
    s_nop 1
    v_mov_b32_dpp v52, v64 quad_perm:[0,1,2,3] row_mask:0x8 bank_mask:0xf
    v_and_or_b32 v86, v52, s7, v10
    buffer_store_dword v86, v11, s[44:47], s77 offen offset:2304
    v_mov_b32_dpp v68, v72 quad_perm:[0,1,2,3] row_mask:0x2 bank_mask:0xf
    s_nop 1
    v_mov_b32_dpp v68, v76 quad_perm:[0,1,2,3] row_mask:0x4 bank_mask:0xf
    s_nop 1
    v_mov_b32_dpp v68, v80 quad_perm:[0,1,2,3] row_mask:0x8 bank_mask:0xf
    v_and_or_b32 v87, v68, s7, v10
    buffer_store_dword v87, v11, s[44:47], s77 offen offset:3328
    s_cmp_lt_u32 s3, 2
    s_cbranch_scc0 L_sk_14
    s_lshl_b32 s12, s3, 6
    v_xor_b32 v5, s12, v16
    v_xor_b32 v6, s12, v20
    v_add_u32 v34, 149248, v5
    v_add_u32 v38, 149248, v6
    v_xor_b32 v5, s12, v17
    v_xor_b32 v6, s12, v21
    v_add_u32 v35, 149248, v5
    v_add_u32 v39, 149248, v6
    ds_read_b64_tr_b16 a[0:1], v34 offset:0
    ds_read_b64_tr_b16 a[2:3], v34 offset:2048
    ds_read_b64_tr_b16 a[16:17], v38 offset:0
    ds_read_b64_tr_b16 a[4:5], v35 offset:0
    ds_read_b64_tr_b16 a[6:7], v35 offset:2048
    ds_read_b64_tr_b16 a[18:19], v39 offset:0
    s_lshl_b32 s12, s3, 7
    s_add_u32 s82, s79, s12
    s_add_u32 s77, s82, 4196608
    s_waitcnt lgkmcnt(0)
    v_mfma_f32_16x16x16_bf16 v[52:55], v[48:49], a[16:17], 0
    v_mfma_f32_16x16x16_bf16 v[56:59], v[48:49], a[18:19], 0
    s_nop 4
    v_mfma_f32_16x16x32_bf16 v[52:55], v[44:47], a[0:3], v[52:55]
    v_mfma_f32_16x16x32_bf16 v[56:59], v[44:47], a[4:7], v[56:59]
    s_nop 7
    v_mov_b32_dpp v52, v56 quad_perm:[0,1,2,3] row_mask:0x2 bank_mask:0xf
    v_and_or_b32 v89, v52, s7, v10
    s_mov_b32 exec_hi, 0
    buffer_store_dword v89, v11, s[44:47], s77 offen offset:2048
    s_add_u32 s82, s82, 2304
    buffer_store_dword v89, v11, s[44:47], s82 offen offset:2048 sc1
    s_mov_b64 exec, -1
L_sk_14:
    s_cmp_lt_u32 s3, 3
    s_cbranch_scc0 L_sk_15
    s_barrier
    buffer_store_dword v84, v11, s[44:47], s83 offen offset:0 sc1
    buffer_store_dword v85, v11, s[44:47], s83 offen offset:1024 sc1
    buffer_store_dword v86, v11, s[44:47], s83 offen offset:2304 sc1
    buffer_store_dword v87, v11, s[44:47], s83 offen offset:3328 sc1
L_sk_15:
    s_cmp_eq_u32 s3, 0
    s_cbranch_scc0 L_sk_16
    buffer_store_dword v88, v11, s[44:47], s79 offen offset:2048 sc1
L_sk_16:
    s_cmp_eq_u32 s3, 0
    s_cbranch_scc0 L_sk_17
    s_add_u32 s12, s75, 1024
    s_mov_b32 m0, 107776
    s_nop 0
    buffer_load_dwordx4 v14, s[92:95], s12 offen nt lds
    s_add_u32 s12, s75, 10240
    s_mov_b32 m0, 108800
    s_nop 0
    buffer_load_dwordx4 v14, s[92:95], s12 offen nt lds
    s_add_u32 s12, s75, 19456
    s_mov_b32 m0, 109824
    s_nop 0
    buffer_load_dwordx4 v14, s[92:95], s12 offen nt lds
    s_add_u32 s12, s75, 28672
    s_mov_b32 m0, 110848
    s_nop 0
    buffer_load_dwordx4 v14, s[92:95], s12 offen nt lds
L_sk_17:
    s_cmp_eq_u32 s3, 2
    s_cbranch_scc0 L_sk_18
    buffer_load_dwordx4 v[96:99], v32, s[44:47], s96 offen
L_sk_18:
    s_cmp_eq_u32 s3, 3
    s_cbranch_scc0 L_sk_19
    s_mov_b32 s84, 0x3ffff
    s_mov_b32 s85, 0x3ffff
    s_add_u32 s82, s88, 4194304
    s_mov_b32 s79, s82
    s_mov_b64 exec, s[84:85]
    s_add_u32 s12, s79, 0
    buffer_load_dwordx4 v[96:99], v30, s[44:47], s12 offen sc1
    s_add_u32 s12, s79, 9216
    buffer_load_dwordx4 v[100:103], v30, s[44:47], s12 offen sc1
    s_add_u32 s12, s79, 18432
    buffer_load_dwordx4 v[104:107], v30, s[44:47], s12 offen sc1
    s_add_u32 s12, s79, 27648
    buffer_load_dwordx4 v[108:111], v30, s[44:47], s12 offen sc1
    s_add_u32 s12, s79, 36864
    buffer_load_dwordx4 v[112:115], v30, s[44:47], s12 offen sc1
    s_add_u32 s12, s79, 46080
    buffer_load_dwordx4 v[116:119], v30, s[44:47], s12 offen sc1
    s_add_u32 s12, s79, 55296
    buffer_load_dwordx4 v[120:123], v30, s[44:47], s12 offen sc1
    s_add_u32 s12, s79, 64512
    buffer_load_dwordx4 v[124:127], v30, s[44:47], s12 offen sc1
    s_mov_b64 exec, -1
    s_barrier
    buffer_store_dword v84, v11, s[44:47], s83 offen offset:0 sc1
    buffer_store_dword v85, v11, s[44:47], s83 offen offset:1024 sc1
    buffer_store_dword v86, v11, s[44:47], s83 offen offset:2304 sc1
    buffer_store_dword v87, v11, s[44:47], s83 offen offset:3328 sc1
    s_mov_b64 exec, s[84:85]
    s_waitcnt vmcnt(4)
    v_xor_b32 v9, s8, v96
    v_bitop3_b32 v9, v97, s9, v9 bitop3:0xbe
    v_bitop3_b32 v9, v98, s10, v9 bitop3:0xbe
    v_bitop3_b32 v9, v99, s11, v9 bitop3:0xbe
    v_bitop3_b32 v9, v100, s8, v9 bitop3:0xbe
    v_bitop3_b32 v9, v101, s9, v9 bitop3:0xbe
    v_bitop3_b32 v9, v102, s10, v9 bitop3:0xbe
    v_bitop3_b32 v9, v103, s11, v9 bitop3:0xbe
    v_bitop3_b32 v9, v104, s8, v9 bitop3:0xbe
    v_bitop3_b32 v9, v105, s9, v9 bitop3:0xbe
    v_bitop3_b32 v9, v106, s10, v9 bitop3:0xbe
    v_bitop3_b32 v9, v107, s11, v9 bitop3:0xbe
    v_bitop3_b32 v9, v108, s8, v9 bitop3:0xbe
    v_bitop3_b32 v9, v109, s9, v9 bitop3:0xbe
    v_bitop3_b32 v9, v110, s10, v9 bitop3:0xbe
    v_bitop3_b32 v9, v111, s11, v9 bitop3:0xbe
    v_bitop3_b32 v9, v112, s8, v9 bitop3:0xbe
    v_bitop3_b32 v9, v113, s9, v9 bitop3:0xbe
    v_bitop3_b32 v9, v114, s10, v9 bitop3:0xbe
    v_bitop3_b32 v9, v115, s11, v9 bitop3:0xbe
    v_bitop3_b32 v9, v116, s8, v9 bitop3:0xbe
    v_bitop3_b32 v9, v117, s9, v9 bitop3:0xbe
    v_bitop3_b32 v9, v118, s10, v9 bitop3:0xbe
    v_bitop3_b32 v9, v119, s11, v9 bitop3:0xbe
    v_bitop3_b32 v9, v120, s8, v9 bitop3:0xbe
    v_bitop3_b32 v9, v121, s9, v9 bitop3:0xbe
    v_bitop3_b32 v9, v122, s10, v9 bitop3:0xbe
    v_bitop3_b32 v9, v123, s11, v9 bitop3:0xbe
    v_bitop3_b32 v9, v124, s8, v9 bitop3:0xbe
    v_bitop3_b32 v9, v125, s9, v9 bitop3:0xbe
    v_bitop3_b32 v9, v126, s10, v9 bitop3:0xbe
    v_bitop3_b32 v9, v127, s11, v9 bitop3:0xbe
    v_and_b32 v9, 0xff, v9
    v_cmp_ne_u32 vcc, 0, v9
    s_mov_b32 s14, 0
    s_and_b64 exec, exec, vcc
    s_cbranch_scc0 L_got_21
L_poll_20:
    s_bitcmp1_b32 s14, 0
    s_cselect_b32 s79, s88, s82
    s_cmp_lt_u32 s14, 64
    s_cselect_b32 s79, s82, s79
    s_add_u32 s12, s79, 0
    buffer_load_dwordx4 v[96:99], v30, s[44:47], s12 offen sc1
    s_add_u32 s12, s79, 9216
    buffer_load_dwordx4 v[100:103], v30, s[44:47], s12 offen sc1
    s_add_u32 s12, s79, 18432
    buffer_load_dwordx4 v[104:107], v30, s[44:47], s12 offen sc1
    s_add_u32 s12, s79, 27648
    buffer_load_dwordx4 v[108:111], v30, s[44:47], s12 offen sc1
    s_add_u32 s12, s79, 36864
    buffer_load_dwordx4 v[112:115], v30, s[44:47], s12 offen sc1
    s_add_u32 s12, s79, 46080
    buffer_load_dwordx4 v[116:119], v30, s[44:47], s12 offen sc1
    s_add_u32 s12, s79, 55296
    buffer_load_dwordx4 v[120:123], v30, s[44:47], s12 offen sc1
    s_add_u32 s12, s79, 64512
    buffer_load_dwordx4 v[124:127], v30, s[44:47], s12 offen sc1
    s_waitcnt vmcnt(0)
    v_xor_b32 v9, s8, v96
    v_bitop3_b32 v9, v97, s9, v9 bitop3:0xbe
    v_bitop3_b32 v9, v98, s10, v9 bitop3:0xbe
    v_bitop3_b32 v9, v99, s11, v9 bitop3:0xbe
    v_bitop3_b32 v9, v100, s8, v9 bitop3:0xbe
    v_bitop3_b32 v9, v101, s9, v9 bitop3:0xbe
    v_bitop3_b32 v9, v102, s10, v9 bitop3:0xbe
    v_bitop3_b32 v9, v103, s11, v9 bitop3:0xbe
    v_bitop3_b32 v9, v104, s8, v9 bitop3:0xbe
    v_bitop3_b32 v9, v105, s9, v9 bitop3:0xbe
    v_bitop3_b32 v9, v106, s10, v9 bitop3:0xbe
    v_bitop3_b32 v9, v107, s11, v9 bitop3:0xbe
    v_bitop3_b32 v9, v108, s8, v9 bitop3:0xbe
    v_bitop3_b32 v9, v109, s9, v9 bitop3:0xbe
    v_bitop3_b32 v9, v110, s10, v9 bitop3:0xbe
    v_bitop3_b32 v9, v111, s11, v9 bitop3:0xbe
    v_bitop3_b32 v9, v112, s8, v9 bitop3:0xbe
    v_bitop3_b32 v9, v113, s9, v9 bitop3:0xbe
    v_bitop3_b32 v9, v114, s10, v9 bitop3:0xbe
    v_bitop3_b32 v9, v115, s11, v9 bitop3:0xbe
    v_bitop3_b32 v9, v116, s8, v9 bitop3:0xbe
    v_bitop3_b32 v9, v117, s9, v9 bitop3:0xbe
    v_bitop3_b32 v9, v118, s10, v9 bitop3:0xbe
    v_bitop3_b32 v9, v119, s11, v9 bitop3:0xbe
    v_bitop3_b32 v9, v120, s8, v9 bitop3:0xbe
    v_bitop3_b32 v9, v121, s9, v9 bitop3:0xbe
    v_bitop3_b32 v9, v122, s10, v9 bitop3:0xbe
    v_bitop3_b32 v9, v123, s11, v9 bitop3:0xbe
    v_bitop3_b32 v9, v124, s8, v9 bitop3:0xbe
    v_bitop3_b32 v9, v125, s9, v9 bitop3:0xbe
    v_bitop3_b32 v9, v126, s10, v9 bitop3:0xbe
    v_bitop3_b32 v9, v127, s11, v9 bitop3:0xbe
    v_and_b32 v9, 0xff, v9
    v_cmp_ne_u32 vcc, 0, v9
    s_add_u32 s14, s14, 1
    s_cmp_lt_u32 s14, 262144
    s_cbranch_scc0 L_got_21
    s_and_b64 exec, exec, vcc
    s_cbranch_scc1 L_poll_20
L_got_21:
    s_mov_b64 exec, -1
    v_and_b32 v96, s7, v96
    v_and_b32 v97, s7, v97
    v_and_b32 v98, s7, v98
    v_and_b32 v99, s7, v99
    v_and_b32 v100, s7, v100
    v_and_b32 v101, s7, v101
    v_and_b32 v102, s7, v102
    v_and_b32 v103, s7, v103
    v_and_b32 v104, s7, v104
    v_and_b32 v105, s7, v105
    v_and_b32 v106, s7, v106
    v_and_b32 v107, s7, v107
    v_and_b32 v108, s7, v108
    v_and_b32 v109, s7, v109
    v_and_b32 v110, s7, v110
    v_and_b32 v111, s7, v111
    v_and_b32 v112, s7, v112
    v_and_b32 v113, s7, v113
    v_and_b32 v114, s7, v114
    v_and_b32 v115, s7, v115
    v_and_b32 v116, s7, v116
    v_and_b32 v117, s7, v117
    v_and_b32 v118, s7, v118
    v_and_b32 v119, s7, v119
    v_and_b32 v120, s7, v120
    v_and_b32 v121, s7, v121
    v_and_b32 v122, s7, v122
    v_and_b32 v123, s7, v123
    v_and_b32 v124, s7, v124
    v_and_b32 v125, s7, v125
    v_and_b32 v126, s7, v126
    v_and_b32 v127, s7, v127
    v_add_f32 v96, v96, v112
    v_add_f32 v97, v97, v113
    v_add_f32 v98, v98, v114
    v_add_f32 v99, v99, v115
    v_add_f32 v100, v100, v116
    v_add_f32 v101, v101, v117
    v_add_f32 v102, v102, v118
    v_add_f32 v103, v103, v119
    v_add_f32 v104, v104, v120
    v_add_f32 v105, v105, v121
    v_add_f32 v106, v106, v122
    v_add_f32 v107, v107, v123
    v_add_f32 v108, v108, v124
    v_add_f32 v109, v109, v125
    v_add_f32 v110, v110, v126
    v_add_f32 v111, v111, v127
    v_add_f32 v96, v96, v104
    v_add_f32 v97, v97, v105
    v_add_f32 v98, v98, v106
    v_add_f32 v99, v99, v107
    v_add_f32 v100, v100, v108
    v_add_f32 v101, v101, v109
    v_add_f32 v102, v102, v110
    v_add_f32 v103, v103, v111
    v_add_f32 v34, v96, v100
    v_add_f32 v35, v97, v101
    v_add_f32 v36, v98, v102
    v_add_f32 v37, v99, v103
    s_nop 0
    v_permlane32_swap_b32 v34, v36
    v_permlane32_swap_b32 v35, v37
    v_add_f32 v34, v34, v36
    v_add_f32 v35, v35, v37
    v_min_u32 v29, 35, v1
    v_lshlrev_b32 v6, 2, v29
    v_add_u32 v6, 162048, v6
    s_mov_b64 exec, s[84:85]
    ds_write_b64 v31, v[34:35]
    s_mov_b64 exec, -1
    v_lshlrev_b32 v29, 1, v29
    v_add_u32 v29, 162560, v29
    s_waitcnt lgkmcnt(0)
    ds_read_b32 v34, v6
    ds_read_b32 v35, v6 offset:144
    s_waitcnt lgkmcnt(0)
    v_mul_f32 v34, 0xbfb8aa3b, v34
    v_exp_f32 v34, v34
    s_nop 0
    v_add_f32 v34, 1.0, v34
    v_rcp_f32 v34, v34
    s_nop 0
    v_mul_f32 v34, v34, v35
    v_cvt_pk_bf16_f32 v34, v34, v34
    ds_write_b16 v29, v34
L_sk_19:
    s_branch L_S_out
L_S_load:
    s_lshl_b32 s12, s80, 8
    s_add_u32 s82, s74, s12
    s_add_u32 s83, s75, s12
    s_lshl_b32 s84, s80, 13
    s_add_u32 s84, s84, 42752
    s_cmp_eq_u32 s80, 3
    s_cselect_b32 s84, 153856, s84
    s_mul_i32 s85, s80, 9216
    s_add_u32 s85, s85, 1280
    s_waitcnt vmcnt(5)
    s_barrier
    s_cmp_eq_u32 s80, 0
    s_cbranch_scc0 L_sk_22
    s_add_u32 s12, s74, 37888
    s_mov_b32 exec_hi, 0
    s_mov_b32 m0, 42240
    s_nop 0
    buffer_load_dwordx4 v14, s[68:71], s12 offen nt lds
    s_mov_b64 exec, -1
L_sk_22:
    s_mul_i32 s12, s80, 8*1152
    s_add_u32 s12, s12, s74
    s_add_u32 s12, s12, 1024
    s_lshl_b32 s13, s80, 10
    s_add_u32 s13, s13, 38144
    s_mov_b32 m0, s13
    s_nop 0
    buffer_load_dwordx4 v14, s[68:71], s12 offen nt lds
    s_add_u32 m0, s85, 0
    s_add_u32 s12, s82, 0
    buffer_load_dwordx4 v14, s[68:71], s12 offen nt lds
    s_add_u32 m0, s85, 4608
    s_add_u32 s12, s82, 128
    buffer_load_dwordx4 v14, s[68:71], s12 offen nt lds
    s_add_u32 m0, s85, 1024
    s_add_u32 s12, s82, 9216
    buffer_load_dwordx4 v14, s[68:71], s12 offen nt lds
    s_add_u32 m0, s85, 5632
    s_add_u32 s12, s82, 9344
    buffer_load_dwordx4 v14, s[68:71], s12 offen nt lds
    s_cmp_eq_u32 s3, 4
    s_cbranch_scc0 L_sk_23
    s_waitcnt vmcnt(6)
L_sk_23:
    s_cmp_lg_u32 s3, 4
    s_cbranch_scc0 L_sk_24
    s_waitcnt vmcnt(5)
L_sk_24:
    s_barrier
    s_barrier
    s_add_u32 m0, s85, 2048
    s_add_u32 s12, s82, 18432
    buffer_load_dwordx4 v14, s[68:71], s12 offen nt lds
    s_add_u32 m0, s85, 6656
    s_add_u32 s12, s82, 18560
    buffer_load_dwordx4 v14, s[68:71], s12 offen nt lds
    s_waitcnt vmcnt(6)
    s_add_u32 m0, s85, 3072
    s_add_u32 s12, s82, 27648
    buffer_load_dwordx4 v14, s[68:71], s12 offen nt lds
    s_waitcnt vmcnt(6)
    s_add_u32 m0, s85, 7680
    s_add_u32 s12, s82, 27776
    buffer_load_dwordx4 v14, s[68:71], s12 offen nt lds
    s_waitcnt vmcnt(6)
    s_add_u32 m0, s85, 4096
    s_add_u32 s12, s82, 36864
    s_mov_b32 exec_hi, 0
    buffer_load_dwordx4 v14, s[68:71], s12 offen nt lds
    s_mov_b64 exec, -1
    s_waitcnt vmcnt(6)
    s_add_u32 m0, s85, 8704
    s_add_u32 s12, s82, 36992
    s_mov_b32 exec_hi, 0
    buffer_load_dwordx4 v14, s[68:71], s12 offen nt lds
    s_mov_b64 exec, -1
    s_waitcnt vmcnt(6)
    s_add_u32 m0, s84, 0
    s_add_u32 s12, s83, 0
    buffer_load_dwordx4 v14, s[92:95], s12 offen nt lds
    s_waitcnt vmcnt(6)
    s_add_u32 m0, s84, 4096
    s_add_u32 s12, s83, 128
    buffer_load_dwordx4 v14, s[92:95], s12 offen nt lds
    s_waitcnt vmcnt(6)
    s_add_u32 m0, s84, 1024
    s_add_u32 s12, s83, 9216
    buffer_load_dwordx4 v14, s[92:95], s12 offen nt lds
    s_waitcnt vmcnt(6)
    s_add_u32 m0, s84, 5120
    s_add_u32 s12, s83, 9344
    buffer_load_dwordx4 v14, s[92:95], s12 offen nt lds
    s_waitcnt vmcnt(6)
    s_add_u32 m0, s84, 2048
    s_add_u32 s12, s83, 18432
    buffer_load_dwordx4 v14, s[92:95], s12 offen nt lds
    s_waitcnt vmcnt(6)
    s_add_u32 m0, s84, 6144
    s_add_u32 s12, s83, 18560
    buffer_load_dwordx4 v14, s[92:95], s12 offen nt lds
    s_waitcnt vmcnt(6)
    s_add_u32 m0, s84, 3072
    s_add_u32 s12, s83, 27648
    buffer_load_dwordx4 v14, s[92:95], s12 offen nt lds
    s_waitcnt vmcnt(6)
    s_add_u32 m0, s84, 7168
    s_add_u32 s12, s83, 27776
    buffer_load_dwordx4 v14, s[92:95], s12 offen nt lds
L_S_out:
    s_mov_b32 s12, 162560
    v_lshl_add_u32 v25, v3, 3, s12
    v_mov_b32 v26, 1152
    s_add_u32 s13, s12, 64
    v_mov_b32 v5, s13
    v_cmp_gt_u32 vcc, 16, v1
    s_nop 1
    v_cndmask_b32 v26, v26, v5, vcc
    s_add_u32 s12, s76, 1280
    v_add_u32 v34, s12, v16
    v_add_u32 v38, s12, v20
    v_add_u32 v35, s12, v17
    v_add_u32 v39, s12, v21
    v_add_u32 v36, s12, v18
    v_add_u32 v40, s12, v22
    v_add_u32 v37, s12, v19
    v_add_u32 v41, s12, v23
    s_lshl_b32 s84, s3, 12
    s_add_u32 s84, s84, 42752
    s_cmp_ge_u32 s3, 6
    s_cselect_b32 s12, 86528, 0
    s_add_u32 s84, s84, s12
    s_cmp_ge_u32 s3, 4
    s_cbranch_scc0 L_sk_25
    s_waitcnt vmcnt(8)
L_sk_25:
    s_waitcnt lgkmcnt(0)
    s_barrier
    s_cmp_eq_u32 s3, 3
    s_cbranch_scc0 L_sk_26
    s_waitcnt vmcnt(0)
L_sk_26:
    ds_read_b64 v[44:45], v25
    ds_read_b64 v[46:47], v25 offset:32
    ds_read_b64 v[48:49], v26
    ds_read_b64_tr_b16 a[0:1], v34 offset:0
    ds_read_b64_tr_b16 a[2:3], v34 offset:2048
    ds_read_b64_tr_b16 a[16:17], v38 offset:0
    ds_read_b64_tr_b16 a[4:5], v35 offset:0
    ds_read_b64_tr_b16 a[6:7], v35 offset:2048
    ds_read_b64_tr_b16 a[18:19], v39 offset:0
    ds_read_b64_tr_b16 a[8:9], v36 offset:0
    ds_read_b64_tr_b16 a[10:11], v36 offset:2048
    ds_read_b64_tr_b16 a[20:21], v40 offset:0
    ds_read_b64_tr_b16 a[12:13], v37 offset:0
    ds_read_b64_tr_b16 a[14:15], v37 offset:2048
    ds_read_b64_tr_b16 a[22:23], v41 offset:0
    s_waitcnt lgkmcnt(0)
    v_mfma_f32_16x16x16_bf16 v[52:55], v[48:49], a[16:17], 0
    v_mfma_f32_16x16x16_bf16 v[56:59], v[48:49], a[18:19], 0
    v_mfma_f32_16x16x16_bf16 v[60:63], v[48:49], a[20:21], 0
    v_mfma_f32_16x16x16_bf16 v[64:67], v[48:49], a[22:23], 0
    s_nop 2
    v_mfma_f32_16x16x32_bf16 v[52:55], v[44:47], a[0:3], v[52:55]
    v_mfma_f32_16x16x32_bf16 v[56:59], v[44:47], a[4:7], v[56:59]
    v_mfma_f32_16x16x32_bf16 v[60:63], v[44:47], a[8:11], v[60:63]
    v_mfma_f32_16x16x32_bf16 v[64:67], v[44:47], a[12:15], v[64:67]
    s_cmp_lt_u32 s3, 2
    s_cbranch_scc0 L_sk_27
    s_lshl_b32 s12, s3, 6
    v_xor_b32 v5, s12, v16
    v_xor_b32 v6, s12, v20
    v_add_u32 v34, 38144, v5
    v_add_u32 v38, 38144, v6
    v_add_u32 v96, 107776, v5
    v_xor_b32 v5, s12, v17
    v_xor_b32 v6, s12, v21
    v_add_u32 v35, 38144, v5
    v_add_u32 v39, 38144, v6
    v_add_u32 v97, 107776, v5
    ds_read_b64_tr_b16 a[48:49], v34 offset:0
    ds_read_b64_tr_b16 a[50:51], v34 offset:2048
    ds_read_b64_tr_b16 a[64:65], v38 offset:0
    ds_read_b64_tr_b16 a[52:53], v35 offset:0
    ds_read_b64_tr_b16 a[54:55], v35 offset:2048
    ds_read_b64_tr_b16 a[66:67], v39 offset:0
    s_waitcnt lgkmcnt(0)
    v_mfma_f32_16x16x16_bf16 v[68:71], v[48:49], a[64:65], 0
    v_mfma_f32_16x16x16_bf16 v[72:75], v[48:49], a[66:67], 0
    s_nop 4
    v_mfma_f32_16x16x32_bf16 v[68:71], v[44:47], a[48:51], v[68:71]
    v_mfma_f32_16x16x32_bf16 v[72:75], v[44:47], a[52:55], v[72:75]
L_sk_27:
    v_add_u32 v34, s84, v16
    v_add_u32 v35, s84, v17
    v_add_u32 v36, s84, v18
    v_add_u32 v37, s84, v19
    s_waitcnt vmcnt(0)
    s_barrier
    s_mov_b32 s79, s96
    buffer_load_dwordx4 v[84:87], v32, s[44:47], s79 offen sc1
    ds_read_b64_tr_b16 a[24:25], v34 offset:0
    ds_read_b64_tr_b16 a[26:27], v34 offset:2048
    ds_read_b64_tr_b16 a[28:29], v35 offset:0
    ds_read_b64_tr_b16 a[30:31], v35 offset:2048
    ds_read_b64_tr_b16 a[32:33], v36 offset:0
    ds_read_b64_tr_b16 a[34:35], v36 offset:2048
    ds_read_b64_tr_b16 a[36:37], v37 offset:0
    ds_read_b64_tr_b16 a[38:39], v37 offset:2048
    s_cmp_lt_u32 s3, 2
    s_cbranch_scc0 L_sk_30
    ds_read_b64_tr_b16 a[72:73], v96
    ds_read_b64_tr_b16 a[74:75], v96 offset:2048
    ds_read_b64_tr_b16 a[76:77], v97
    ds_read_b64_tr_b16 a[78:79], v97 offset:2048
L_sk_30:
    s_waitcnt vmcnt(0)
    v_xor_b32 v9, s8, v84
    v_bitop3_b32 v9, v85, s9, v9 bitop3:0xbe
    v_bitop3_b32 v9, v86, s10, v9 bitop3:0xbe
    v_bitop3_b32 v9, v87, s11, v9 bitop3:0xbe
    v_and_b32 v9, 0xff, v9
    v_cmp_ne_u32 vcc, 0, v9
    s_mov_b32 s14, 0
    s_and_b64 exec, exec, vcc
    s_cbranch_scc0 L_got_29
L_poll_28:
    s_bitcmp1_b32 s14, 0
    s_cselect_b32 s79, s97, s96
    s_cmp_lt_u32 s14, 64
    s_cselect_b32 s79, s96, s79
    buffer_load_dwordx4 v[84:87], v32, s[44:47], s79 offen sc1
    s_waitcnt vmcnt(0)
    v_xor_b32 v9, s8, v84
    v_bitop3_b32 v9, v85, s9, v9 bitop3:0xbe
    v_bitop3_b32 v9, v86, s10, v9 bitop3:0xbe
    v_bitop3_b32 v9, v87, s11, v9 bitop3:0xbe
    v_and_b32 v9, 0xff, v9
    v_cmp_ne_u32 vcc, 0, v9
    s_add_u32 s14, s14, 1
    s_cmp_lt_u32 s14, 262144
    s_cbranch_scc0 L_got_29
    s_and_b64 exec, exec, vcc
    s_cbranch_scc1 L_poll_28
L_got_29:
    s_mov_b64 exec, -1
    s_cmp_eq_u32 s3, 7
    s_cbranch_scc0 L_sk_31
    s_and_b32 s12, s4, 7
    s_lshl_b32 s12, s12, 7
    s_add_u32 s12, s12, 1007616
    v_lshlrev_b32 v5, 10, v1
    v_mov_b32 v6, 1
    s_mov_b64 exec, 0xff
    buffer_atomic_add v6, v5, s[44:47], s12 offen sc1
    s_mov_b64 exec, -1
L_sk_31:
    v_and_b32 v84, s7, v84
    v_and_b32 v85, s7, v85
    v_and_b32 v86, s7, v86
    v_and_b32 v87, s7, v87
    v_add_f32_dpp v84, v84, v84 row_ror:4 row_mask:0xf bank_mask:0xf
    v_add_f32_dpp v85, v85, v85 row_ror:4 row_mask:0xf bank_mask:0xf
    v_add_f32_dpp v86, v86, v86 row_ror:4 row_mask:0xf bank_mask:0xf
    v_add_f32_dpp v87, v87, v87 row_ror:4 row_mask:0xf bank_mask:0xf
    v_add_f32_dpp v84, v84, v84 row_ror:8 row_mask:0xf bank_mask:0xf
    v_add_f32_dpp v85, v85, v85 row_ror:8 row_mask:0xf bank_mask:0xf
    v_add_f32_dpp v86, v86, v86 row_ror:8 row_mask:0xf bank_mask:0xf
    v_add_f32_dpp v87, v87, v87 row_ror:8 row_mask:0xf bank_mask:0xf
    v_cvt_pk_bf16_f32 v88, v84, v85
    v_cvt_pk_bf16_f32 v89, v86, v87
    s_mul_i32 s79, s2, 2304
    s_add_u32 s79, s79, 393216
    v_mov_b32_dpp v92, v88 quad_perm:[0,0,2,2] row_mask:0xf bank_mask:0xf
    v_mov_b32_dpp v93, v89 quad_perm:[0,0,2,2] row_mask:0xf bank_mask:0xf
    v_mov_b32_dpp v94, v88 quad_perm:[1,1,3,3] row_mask:0xf bank_mask:0xf
    v_mov_b32_dpp v95, v89 quad_perm:[1,1,3,3] row_mask:0xf bank_mask:0xf
    s_lshl_b32 s12, s3, 8
    s_add_u32 s12, s12, s79
    s_waitcnt lgkmcnt(0)
    v_mfma_f32_16x16x32_bf16 v[52:55], v[92:95], a[24:27], v[52:55]
    v_mfma_f32_16x16x32_bf16 v[56:59], v[92:95], a[28:31], v[56:59]
    v_mfma_f32_16x16x32_bf16 v[60:63], v[92:95], a[32:35], v[60:63]
    v_mfma_f32_16x16x32_bf16 v[64:67], v[92:95], a[36:39], v[64:67]
    s_cmp_lt_u32 s3, 2
    s_cbranch_scc0 L_sk_32
    v_mfma_f32_16x16x32_bf16 v[68:71], v[92:95], a[72:75], v[68:71]
    v_mfma_f32_16x16x32_bf16 v[72:75], v[92:95], a[76:79], v[72:75]
L_sk_32:
    s_nop 3
    v_mov_b32_dpp v52, v56 quad_perm:[0,1,2,3] row_mask:0x2 bank_mask:0xf
    s_nop 1
    v_mov_b32_dpp v52, v60 quad_perm:[0,1,2,3] row_mask:0x4 bank_mask:0xf
    s_nop 1
    v_mov_b32_dpp v52, v64 quad_perm:[0,1,2,3] row_mask:0x8 bank_mask:0xf
    v_and_or_b32 v52, v52, s7, v10
    buffer_store_dword v52, v11, s[44:47], s12 offen sc1
    s_cmp_lt_u32 s3, 2
    s_cbranch_scc0 L_sk_33
    s_lshl_b32 s13, s3, 7
    s_add_u32 s13, s13, s79
    v_mov_b32_dpp v68, v72 quad_perm:[0,1,2,3] row_mask:0x2 bank_mask:0xf
    v_and_or_b32 v68, v68, s7, v10
    s_mov_b32 exec_hi, 0
    buffer_store_dword v68, v11, s[44:47], s13 offen offset:2048 sc1
    s_mov_b64 exec, -1
L_sk_33:
    s_endpgm
L_S1:
L_P:
    v_lshlrev_b32 v12, 4, v1
    v_lshlrev_b32 v11, 2, v1
    s_lshr_b32 s74, s5, 1
    s_lshl_b32 s12, s4, 3
    s_add_u32 s74, s74, s12
    s_and_b32 s75, s5, 1
    s_lshl_b32 s76, s74, 7
    s_add_u32 s76, s76, s3
    s_lshl_b32 s12, s75, 6
    s_xor_b32 s13, s12, 64
    s_add_u32 s77, s76, s13
    s_add_u32 s76, s76, s12
    s_lshl_b32 s76, s76, 10
    s_lshl_b32 s77, s77, 10
    s_mul_i32 s78, s3, 1056
    s_lshl_b32 s12, s4, 10
    s_lshl_b32 s13, s5, 3
    s_add_u32 s13, s13, s3
    s_lshl_b32 s13, s13, 13
    s_add_u32 s79, s12, s13
    v_mov_b32 v13, v12
    s_waitcnt lgkmcnt(0)
    s_load_dword s6, s[40:41], 0
    s_mov_b32 s44, s40
    s_mov_b32 s45, s41
    s_mov_b32 s46, 7340032
    s_mov_b32 s47, 0x20000
    s_mov_b32 s68, s22
    s_mov_b32 s69, s23
    s_mov_b32 s70, 4194304
    s_mov_b32 s71, 0x20000
    s_cmp_eq_u32 s3, 6
    s_cbranch_scc0 L_sk_34
    s_lshl_b32 s12, s72, 2
    s_add_u32 s12, s12, s73
    s_lshl_b32 s12, s12, 9
    s_add_u32 s12, s12, 262144
    s_mov_b32 exec_hi, 0
    buffer_load_dwordx4 v[84:87], v12, s[44:47], s12 offen
    s_mov_b64 exec, -1
L_sk_34:
L_P0:
    buffer_load_dwordx4 v[64:67], v13, s[68:71], s79 offen
    s_add_u32 s79, s79, 1048576
    buffer_load_dwordx4 v[68:71], v13, s[68:71], s79 offen
    s_add_u32 s79, s79, 1048576
    buffer_load_dwordx4 v[72:75], v13, s[68:71], s79 offen
    s_add_u32 s79, s79, 1048576
    buffer_load_dwordx4 v[76:79], v13, s[68:71], s79 offen
    v_mov_b32 v108, 0
    v_mov_b32 v109, 0
    v_mov_b32 v110, 0
    v_mov_b32 v111, 0
    s_lshl_b32 s90, s75, 13
    s_lshl_b32 s12, s4, 10
    s_add_u32 s90, s90, s12
    s_add_u32 s90, s90, 987136
    s_add_u32 s91, s12, 1007616
    s_lshl_b32 s12, s5, 3
    s_add_u32 s12, s12, s3
    s_cmp_eq_u32 s12, 1
    s_cbranch_scc0 L_sk_35
    s_mov_b64 exec, -1
    buffer_store_dwordx4 v[108:111], v12, s[44:47], s90 offen sc1
    s_mov_b64 exec, -1
L_sk_35:
    s_cmp_eq_u32 s12, 9
    s_cbranch_scc0 L_sk_36
    s_mov_b64 exec, -1
    buffer_store_dwordx4 v[108:111], v12, s[44:47], s90 offen sc1
    s_mov_b64 exec, -1
L_sk_36:
    s_cmp_eq_u32 s12, 2
    s_cbranch_scc0 L_sk_37
    s_mov_b64 exec, -1
    buffer_store_dwordx4 v[108:111], v12, s[44:47], s91 offen sc1
    s_mov_b64 exec, -1
L_sk_37:
    s_mov_b32 s52, s18
    s_mov_b32 s53, s19
    s_mov_b32 s54, 8388608
    s_mov_b32 s55, 0x20000
    s_mov_b32 s56, s24
    s_mov_b32 s57, s25
    s_mov_b32 s58, 4194304
    s_mov_b32 s59, 0x20000
    s_mov_b32 s48, s16
    s_mov_b32 s49, s17
    s_mov_b32 s50, 1152
    s_mov_b32 s51, 0x20000
    v_lshlrev_b32 v20, 7, v1
    s_lshl_b32 s12, s3, 4
    v_add_u32 v5, s12, v2
    v_mul_u32_u24 v5, 1056, v5
    v_lshl_add_u32 v15, v3, 4, v5
    v_lshrrev_b32 v5, 2, v2
    v_lshl_add_u32 v5, v3, 2, v5
    v_mul_u32_u24 v5, 1056, v5
    v_and_b32 v6, 3, v2
    v_lshl_add_u32 v5, v6, 3, v5
    s_lshl_b32 s12, s3, 7
    v_add_u32 v16, s12, v5
    v_add_u32 v17, 67584, v16
    v_bfe_u32 v5, v1, 1, 2
    s_lshl_b32 s12, s3, 1
    v_xor_b32 v6, s12, v5
    v_lshlrev_b32 v6, 4, v6
    v_lshl_add_u32 v6, v5, 8, v6
    v_lshrrev_b32 v5, 3, v1
    v_mul_u32_u24 v5, 1088, v5
    v_add_u32 v6, v6, v5
    v_and_b32 v5, 1, v1
    v_lshl_add_u32 v6, v5, 3, v6
    v_add_u32 v18, 135168, v6
    v_xor_b32 v5, v2, v3
    v_lshlrev_b32 v5, 4, v5
    v_lshl_add_u32 v5, v3, 8, v5
    v_add_u32 v19, 135168, v5
    s_and_b32 s12, s3, 1
    s_lshl_b32 s12, s12, 2
    v_add_u32 v5, s12, v3
    v_lshlrev_b32 v5, 1, v5
    v_xor_b32 v5, v5, v2
    v_lshlrev_b32 v5, 4, v5
    v_lshl_add_u32 v7, v3, 13, v5
    v_lshrrev_b32 v5, 2, v2
    v_and_b32 v6, 1, v3
    v_lshl_add_u32 v6, v6, 2, v5
    v_lshlrev_b32 v6, 1, v6
    v_bfe_u32 v4, v2, 1, 1
    s_and_b32 s12, s3, 3
    s_lshl_b32 s12, s12, 2
    v_add_u32 v4, s12, v4
    v_xor_b32 v6, v6, v4
    v_lshlrev_b32 v6, 4, v6
    v_lshl_add_u32 v6, v5, 8, v6
    v_lshl_add_u32 v6, v3, 10, v6
    v_and_b32 v5, 1, v2
    v_lshl_add_u32 v8, v5, 3, v6
    v_lshlrev_b32 v5, 5, v2
    v_add_u32 v31, 158848, v5
    s_lshl_b32 s12, s3, 2
    v_add_u32 v30, s12, v31
    s_lshr_b32 s12, s3, 1
    s_lshl_b32 s12, s12, 10
    s_and_b32 s13, s3, 1
    s_lshl_b32 s13, s13, 3
    s_add_u32 s12, s12, s13
    v_add_u32 v33, 154752, v12
    v_add_u32 v32, s12, v33
    s_mul_i32 s12, s3, 2304
    s_add_u32 s12, s12, 73728
    v_mul_u32_u24 v5, 144, v2
    v_lshl_add_u32 v5, v3, 3, v5
    v_add_u32 v34, s12, v5
    v_lshrrev_b32 v5, 3, v1
    v_and_b32 v6, 7, v1
    v_lshlrev_b32 v6, 4, v6
    v_lshl_add_u32 v36, v5, 16, v6
    v_mul_u32_u24 v5, 144, v5
    v_add3_u32 v35, v5, v6, s12
    v_lshlrev_b32 v5, 4, v2
    v_lshl_add_u32 v37, v3, 10, v5
    v_lshrrev_b32 v6, 3, v2
    v_lshl_add_u32 v6, v6, 2, v3
    v_lshlrev_b32 v38, 9, v6
    v_lshrrev_b32 v5, 2, v2
    v_lshlrev_b32 v5, 4, v5
    v_and_b32 v6, 1, v2
    v_lshl_add_u32 v5, v6, 3, v5
    v_bfe_u32 v6, v2, 1, 1
    v_lshl_add_u32 v5, v6, 1, v5
    v_lshrrev_b32 v6, 1, v3
    v_lshl_add_u32 v5, v6, 2, v5
    v_and_b32 v6, 1, v3
    v_add_u32 v5, v5, v6
    s_mul_i32 s12, s3, 272
    s_add_u32 s12, s12, 152576
    v_lshl_add_u32 v39, v5, 2, s12
    v_lshlrev_b32 v6, 4, v6
    v_add_u32 v41, 158848, v6
    v_xor_b32 v42, 16, v41
    v_and_b32 v5, 7, v2
    v_mul_u32_u24 v5, 272, v5
    v_lshl_add_u32 v5, v3, 4, v5
    v_add_u32 v40, 152576, v5
    s_lshl_b32 s80, s99, 7
    s_lshl_b32 s12, s3, 2
    s_add_u32 s80, s80, s12
    s_lshl_b32 s80, s80, 13
    s_lshl_b32 s12, s98, 8
    s_add_u32 s80, s80, s12
    s_lshl_b32 s81, s3, 10
    s_cmp_lt_u32 s3, 6
    s_cbranch_scc0 L_sk_38
    s_lshl_b32 s12, s4, 4
    s_add_u32 s12, s12, s5
    s_mul_i32 s12, s12, 4608
    s_add_u32 s12, s12, s81
    s_add_u32 s12, s12, 5242880
    s_cmp_eq_u32 s3, 5
    s_cbranch_scc0 L_sk_39
    s_lshl_b32 s12, s98, 2
    s_add_u32 s12, s12, s99
    s_lshl_b32 s12, s12, 9
    s_add_u32 s12, s12, 327680
L_sk_39:
    s_cmp_ge_u32 s3, 4
    s_cbranch_scc0 L_sk_40
    s_mov_b32 exec_hi, 0
L_sk_40:
    buffer_load_dwordx4 v[112:115], v12, s[44:47], s12 offen
    s_mov_b64 exec, -1
L_sk_38:
    s_add_u32 m0, s78, 0
    s_add_u32 s12, s76, 0
    buffer_load_dwordx4 v12, s[52:55], s12 offen  lds
    s_add_u32 m0, s78, 8448
    s_add_u32 s12, s76, 8192
    buffer_load_dwordx4 v12, s[52:55], s12 offen  lds
    s_add_u32 m0, s78, 16896
    s_add_u32 s12, s76, 16384
    buffer_load_dwordx4 v12, s[52:55], s12 offen  lds
    s_add_u32 m0, s78, 25344
    s_add_u32 s12, s76, 24576
    buffer_load_dwordx4 v12, s[52:55], s12 offen  lds
    s_add_u32 m0, s78, 33792
    s_add_u32 s12, s76, 32768
    buffer_load_dwordx4 v12, s[52:55], s12 offen  lds
    s_add_u32 m0, s78, 42240
    s_add_u32 s12, s76, 40960
    buffer_load_dwordx4 v12, s[52:55], s12 offen  lds
    s_add_u32 m0, s78, 50688
    s_add_u32 s12, s76, 49152
    buffer_load_dwordx4 v12, s[52:55], s12 offen  lds
    s_add_u32 m0, s78, 59136
    s_add_u32 s12, s76, 57344
    buffer_load_dwordx4 v12, s[52:55], s12 offen  lds
    s_barrier
    s_add_u32 m0, s78, 126720
    s_add_u32 s12, s77, 57344
    buffer_load_dwordx4 v12, s[52:55], s12 offen  lds
    s_add_u32 m0, s78, 118272
    s_add_u32 s12, s77, 49152
    buffer_load_dwordx4 v12, s[52:55], s12 offen  lds
    s_add_u32 m0, s78, 109824
    s_add_u32 s12, s77, 40960
    buffer_load_dwordx4 v12, s[52:55], s12 offen  lds
    s_add_u32 m0, s78, 101376
    s_add_u32 s12, s77, 32768
    buffer_load_dwordx4 v12, s[52:55], s12 offen  lds
    s_add_u32 m0, s78, 92928
    s_add_u32 s12, s77, 24576
    buffer_load_dwordx4 v12, s[52:55], s12 offen  lds
    s_add_u32 m0, s78, 84480
    s_add_u32 s12, s77, 16384
    buffer_load_dwordx4 v12, s[52:55], s12 offen  lds
    s_add_u32 m0, s78, 76032
    s_add_u32 s12, s77, 8192
    buffer_load_dwordx4 v12, s[52:55], s12 offen  lds
    s_add_u32 m0, s78, 67584
    s_add_u32 s12, s77, 0
    buffer_load_dwordx4 v12, s[52:55], s12 offen  lds
    s_waitcnt lgkmcnt(0)
    s_add_u32 s6, s6, 0x9e3779b9
    s_bfe_u32 s8, s6, 0x80000
    s_bfe_u32 s9, s6, 0x80008
    s_bfe_u32 s10, s6, 0x80010
    s_bfe_u32 s11, s6, 0x80018
    v_and_b32 v10, 3, v1
    v_lshlrev_b32 v10, 3, v10
    v_lshrrev_b32 v10, v10, s6
    v_and_b32 v10, 0xff, v10
    s_mov_b32 s7, 0xffffff00
    v_bfe_u32 v5, v10, 0, 1
    v_bfe_u32 v6, v10, 1, 1
    v_lshl_or_b32 v22, v6, 16, v5
    v_bfe_u32 v5, v10, 2, 1
    v_bfe_u32 v6, v10, 3, 1
    v_lshl_or_b32 v23, v6, 16, v5
    v_bfe_u32 v5, v10, 4, 1
    v_bfe_u32 v6, v10, 5, 1
    v_lshl_or_b32 v24, v6, 16, v5
    v_bfe_u32 v5, v10, 6, 1
    v_bfe_u32 v6, v10, 7, 1
    v_lshl_or_b32 v25, v6, 16, v5
    s_lshl_b32 s79, s75, 4
    s_lshl_b32 s12, s3, 1
    s_add_u32 s79, s79, s12
    s_lshl_b32 s79, s79, 11
    s_add_u32 s79, s79, 6291456
    s_waitcnt vmcnt(8)
    s_barrier
    buffer_load_dwordx4 v[48:51], v12, s[44:47], s79 offen offset:0 sc1
    buffer_load_dwordx4 v[52:55], v12, s[44:47], s79 offen offset:1024 sc1
    buffer_load_dwordx4 v[56:59], v12, s[44:47], s79 offen offset:2048 sc1
    buffer_load_dwordx4 v[60:63], v12, s[44:47], s79 offen offset:3072 sc1
    s_cmp_lt_u32 s3, 4
    s_cbranch_scc0 L_sk_43
    ds_read_b128 a[0:3], v15 offset:0
    ds_read_b128 a[4:7], v15 offset:64
    ds_read_b128 a[8:11], v15 offset:128
    ds_read_b128 a[12:15], v15 offset:192
    ds_read_b128 a[16:19], v15 offset:256
    ds_read_b128 a[20:23], v15 offset:320
    ds_read_b128 a[24:27], v15 offset:384
    ds_read_b128 a[28:31], v15 offset:448
    ds_read_b128 a[32:35], v15 offset:512
    ds_read_b128 a[36:39], v15 offset:576
    ds_read_b128 a[40:43], v15 offset:640
    ds_read_b128 a[44:47], v15 offset:704
    ds_read_b128 a[48:51], v15 offset:768
    ds_read_b128 a[52:55], v15 offset:832
    ds_read_b128 a[56:59], v15 offset:896
    ds_read_b128 a[60:63], v15 offset:960
L_sk_43:
    ds_read_b64_tr_b16 a[64:65], v16 offset:0
    ds_read_b64_tr_b16 a[66:67], v16 offset:16896
    ds_read_b64_tr_b16 a[68:69], v16 offset:32
    ds_read_b64_tr_b16 a[70:71], v16 offset:16928
    ds_read_b64_tr_b16 a[72:73], v16 offset:64
    ds_read_b64_tr_b16 a[74:75], v16 offset:16960
    ds_read_b64_tr_b16 a[76:77], v16 offset:96
    ds_read_b64_tr_b16 a[78:79], v16 offset:16992
    ds_read_b64_tr_b16 a[80:81], v16 offset:33792
    ds_read_b64_tr_b16 a[82:83], v16 offset:50688
    ds_read_b64_tr_b16 a[84:85], v16 offset:33824
    ds_read_b64_tr_b16 a[86:87], v16 offset:50720
    ds_read_b64_tr_b16 a[88:89], v16 offset:33856
    ds_read_b64_tr_b16 a[90:91], v16 offset:50752
    ds_read_b64_tr_b16 a[92:93], v16 offset:33888
    ds_read_b64_tr_b16 a[94:95], v16 offset:50784
    s_waitcnt vmcnt(4) lgkmcnt(0)
    s_barrier
    s_cmp_ge_u32 s3, 4
    s_cbranch_scc0 L_sk_44
    ds_read_b128 a[0:3], v15 offset:0
    ds_read_b128 a[4:7], v15 offset:64
    ds_read_b128 a[8:11], v15 offset:128
    ds_read_b128 a[12:15], v15 offset:192
    ds_read_b128 a[16:19], v15 offset:256
    ds_read_b128 a[20:23], v15 offset:320
    ds_read_b128 a[24:27], v15 offset:384
    ds_read_b128 a[28:31], v15 offset:448
    ds_read_b128 a[32:35], v15 offset:512
    ds_read_b128 a[36:39], v15 offset:576
    ds_read_b128 a[40:43], v15 offset:640
    ds_read_b128 a[44:47], v15 offset:704
    ds_read_b128 a[48:51], v15 offset:768
    ds_read_b128 a[52:55], v15 offset:832
    ds_read_b128 a[56:59], v15 offset:896
    ds_read_b128 a[60:63], v15 offset:960
L_sk_44:
    ds_read_b64_tr_b16 a[96:97], v17 offset:0
    ds_read_b64_tr_b16 a[98:99], v17 offset:16896
    ds_read_b64_tr_b16 a[100:101], v17 offset:32
    ds_read_b64_tr_b16 a[102:103], v17 offset:16928
    ds_read_b64_tr_b16 a[104:105], v17 offset:64
    ds_read_b64_tr_b16 a[106:107], v17 offset:16960
    ds_read_b64_tr_b16 a[108:109], v17 offset:96
    ds_read_b64_tr_b16 a[110:111], v17 offset:16992
    ds_read_b64_tr_b16 a[112:113], v17 offset:33792
    ds_read_b64_tr_b16 a[114:115], v17 offset:50688
    ds_read_b64_tr_b16 a[116:117], v17 offset:33824
    ds_read_b64_tr_b16 a[118:119], v17 offset:50720
    ds_read_b64_tr_b16 a[120:121], v17 offset:33856
    ds_read_b64_tr_b16 a[122:123], v17 offset:50752
    ds_read_b64_tr_b16 a[124:125], v17 offset:33888
    ds_read_b64_tr_b16 a[126:127], v17 offset:50784
    s_waitcnt vmcnt(0)
    v_xor_b32 v9, s8, v48
    v_bitop3_b32 v9, v49, s9, v9 bitop3:0xbe
    v_bitop3_b32 v9, v50, s10, v9 bitop3:0xbe
    v_bitop3_b32 v9, v51, s11, v9 bitop3:0xbe
    v_bitop3_b32 v9, v52, s8, v9 bitop3:0xbe
    v_bitop3_b32 v9, v53, s9, v9 bitop3:0xbe
    v_bitop3_b32 v9, v54, s10, v9 bitop3:0xbe
    v_bitop3_b32 v9, v55, s11, v9 bitop3:0xbe
    v_bitop3_b32 v9, v56, s8, v9 bitop3:0xbe
    v_bitop3_b32 v9, v57, s9, v9 bitop3:0xbe
    v_bitop3_b32 v9, v58, s10, v9 bitop3:0xbe
    v_bitop3_b32 v9, v59, s11, v9 bitop3:0xbe
    v_bitop3_b32 v9, v60, s8, v9 bitop3:0xbe
    v_bitop3_b32 v9, v61, s9, v9 bitop3:0xbe
    v_bitop3_b32 v9, v62, s10, v9 bitop3:0xbe
    v_bitop3_b32 v9, v63, s11, v9 bitop3:0xbe
    v_and_b32 v9, 0xff, v9
    v_cmp_ne_u32 vcc, 0, v9
    s_mov_b32 s14, 0
    s_and_b64 exec, exec, vcc
    s_cbranch_scc0 L_got_42
L_poll_41:
    buffer_load_dwordx4 v[48:51], v12, s[44:47], s79 offen offset:0 sc1
    buffer_load_dwordx4 v[52:55], v12, s[44:47], s79 offen offset:1024 sc1
    buffer_load_dwordx4 v[56:59], v12, s[44:47], s79 offen offset:2048 sc1
    buffer_load_dwordx4 v[60:63], v12, s[44:47], s79 offen offset:3072 sc1
    s_waitcnt vmcnt(0)
    v_xor_b32 v9, s8, v48
    v_bitop3_b32 v9, v49, s9, v9 bitop3:0xbe
    v_bitop3_b32 v9, v50, s10, v9 bitop3:0xbe
    v_bitop3_b32 v9, v51, s11, v9 bitop3:0xbe
    v_bitop3_b32 v9, v52, s8, v9 bitop3:0xbe
    v_bitop3_b32 v9, v53, s9, v9 bitop3:0xbe
    v_bitop3_b32 v9, v54, s10, v9 bitop3:0xbe
    v_bitop3_b32 v9, v55, s11, v9 bitop3:0xbe
    v_bitop3_b32 v9, v56, s8, v9 bitop3:0xbe
    v_bitop3_b32 v9, v57, s9, v9 bitop3:0xbe
    v_bitop3_b32 v9, v58, s10, v9 bitop3:0xbe
    v_bitop3_b32 v9, v59, s11, v9 bitop3:0xbe
    v_bitop3_b32 v9, v60, s8, v9 bitop3:0xbe
    v_bitop3_b32 v9, v61, s9, v9 bitop3:0xbe
    v_bitop3_b32 v9, v62, s10, v9 bitop3:0xbe
    v_bitop3_b32 v9, v63, s11, v9 bitop3:0xbe
    v_and_b32 v9, 0xff, v9
    v_cmp_ne_u32 vcc, 0, v9
    s_add_u32 s14, s14, 1
    s_cmp_lt_u32 s14, 262144
    s_cbranch_scc0 L_got_42
    s_and_b64 exec, exec, vcc
    s_cbranch_scc1 L_poll_41
L_got_42:
    s_mov_b64 exec, -1
    s_mov_b32 s15, 0x07060302
    v_perm_b32 v48, v49, v48, s15
    v_perm_b32 v49, v51, v50, s15
    v_perm_b32 v50, v53, v52, s15
    v_perm_b32 v51, v55, v54, s15
    v_perm_b32 v52, v57, v56, s15
    v_perm_b32 v53, v59, v58, s15
    v_perm_b32 v54, v61, v60, s15
    v_perm_b32 v55, v63, v62, s15
    v_xor_b32 v5, 16, v18
    ds_write_b64 v18, v[48:49]
    ds_write_b64 v18, v[50:51] offset:8704
    ds_write_b64 v5, v[52:53]
    ds_write_b64 v5, v[54:55] offset:8704
    s_add_u32 m0, s81, 0
    s_add_u32 s12, s80, 0
    buffer_load_dwordx4 v7, s[56:59], s12 offen nt lds
    s_add_u32 m0, s81, 8192
    s_add_u32 s12, s80, 262144
    buffer_load_dwordx4 v7, s[56:59], s12 offen nt lds
    s_add_u32 m0, s81, 16384
    s_add_u32 s12, s80, 524288
    buffer_load_dwordx4 v7, s[56:59], s12 offen nt lds
    s_add_u32 m0, s81, 24576
    s_add_u32 s12, s80, 786432
    buffer_load_dwordx4 v7, s[56:59], s12 offen nt lds
    s_waitcnt lgkmcnt(0)
    s_barrier
    ds_read_b128 v[64:67], v19 offset:0
    ds_read_b128 v[68:71], v19 offset:1088
    ds_read_b128 v[72:75], v19 offset:2176
    ds_read_b128 v[76:79], v19 offset:3264
    s_waitcnt lgkmcnt(3)
    v_mfma_f32_16x16x32_bf16 v[80:83], a[0:3], v[64:67], 0
    ds_read_b128 v[64:67], v19 offset:4352
    s_waitcnt lgkmcnt(3)
    v_mfma_f32_16x16x32_bf16 v[80:83], a[4:7], v[68:71], v[80:83]
    ds_read_b128 v[68:71], v19 offset:5440
    s_waitcnt lgkmcnt(3)
    v_mfma_f32_16x16x32_bf16 v[80:83], a[8:11], v[72:75], v[80:83]
    ds_read_b128 v[72:75], v19 offset:6528
    s_waitcnt lgkmcnt(3)
    v_mfma_f32_16x16x32_bf16 v[80:83], a[12:15], v[76:79], v[80:83]
    ds_read_b128 v[76:79], v19 offset:7616
    s_waitcnt lgkmcnt(3)
    v_mfma_f32_16x16x32_bf16 v[80:83], a[16:19], v[64:67], v[80:83]
    ds_read_b128 v[64:67], v19 offset:8704
    s_waitcnt lgkmcnt(3)
    v_mfma_f32_16x16x32_bf16 v[80:83], a[20:23], v[68:71], v[80:83]
    ds_read_b128 v[68:71], v19 offset:9792
    s_waitcnt lgkmcnt(3)
    v_mfma_f32_16x16x32_bf16 v[80:83], a[24:27], v[72:75], v[80:83]
    ds_read_b128 v[72:75], v19 offset:10880
    s_waitcnt lgkmcnt(3)
    v_mfma_f32_16x16x32_bf16 v[80:83], a[28:31], v[76:79], v[80:83]
    ds_read_b128 v[76:79], v19 offset:11968
    s_waitcnt lgkmcnt(3)
    v_mfma_f32_16x16x32_bf16 v[80:83], a[32:35], v[64:67], v[80:83]
    ds_read_b128 v[64:67], v19 offset:13056
    s_waitcnt lgkmcnt(3)
    v_mfma_f32_16x16x32_bf16 v[80:83], a[36:39], v[68:71], v[80:83]
    ds_read_b128 v[68:71], v19 offset:14144
    s_waitcnt lgkmcnt(3)
    v_mfma_f32_16x16x32_bf16 v[80:83], a[40:43], v[72:75], v[80:83]
    ds_read_b128 v[72:75], v19 offset:15232
    s_waitcnt lgkmcnt(3)
    v_mfma_f32_16x16x32_bf16 v[80:83], a[44:47], v[76:79], v[80:83]
    ds_read_b128 v[76:79], v19 offset:16320
    s_waitcnt lgkmcnt(3)
    v_mfma_f32_16x16x32_bf16 v[80:83], a[48:51], v[64:67], v[80:83]
    s_waitcnt lgkmcnt(2)
    v_mfma_f32_16x16x32_bf16 v[80:83], a[52:55], v[68:71], v[80:83]
    s_waitcnt lgkmcnt(1)
    v_mfma_f32_16x16x32_bf16 v[80:83], a[56:59], v[72:75], v[80:83]
    s_waitcnt lgkmcnt(0)
    v_mfma_f32_16x16x32_bf16 v[80:83], a[60:63], v[76:79], v[80:83]
    s_mov_b32 s15, 0x3e0293ee
    s_nop 6
    v_max3_f32 v28, v80, v81, v82
    v_max_f32 v28, v28, v83
    v_mov_b32 v5, v28
    s_nop 1
    v_permlane16_swap_b32 v28, v5
    v_max_f32 v28, v28, v5
    v_mov_b32 v5, v28
    s_nop 1
    v_permlane32_swap_b32 v28, v5
    v_max_f32 v28, v28, v5
    s_mov_b64 exec, 0xffff
    ds_write_b32 v30, v28
    s_mov_b64 exec, -1
    s_waitcnt lgkmcnt(0)
    s_barrier
    ds_read_b128 v[64:67], v31
    ds_read_b128 v[68:71], v31 offset:16
    s_waitcnt lgkmcnt(0)
    v_max3_f32 v28, v64, v65, v66
    v_max3_f32 v5, v67, v68, v69
    v_max3_f32 v28, v28, v70, v71
    v_max_f32 v28, v28, v5
    v_mul_f32 v29, s15, v28
    v_fma_f32 v80, v80, s15, -v29
    v_fma_f32 v81, v81, s15, -v29
    v_fma_f32 v82, v82, s15, -v29
    v_fma_f32 v83, v83, s15, -v29
    v_exp_f32 v80, v80
    v_exp_f32 v81, v81
    v_exp_f32 v82, v82
    v_exp_f32 v83, v83
    v_cvt_pk_bf16_f32 v80, v80, v81
    v_cvt_pk_bf16_f32 v81, v82, v83
    ds_write_b64 v32, v[80:81]
    s_waitcnt lgkmcnt(0)
    s_barrier
    ds_read_b128 v[64:67], v33 offset:0
    ds_read_b128 v[68:71], v33 offset:1024
    ds_read_b128 v[72:75], v33 offset:2048
    ds_read_b128 v[76:79], v33 offset:3072
    s_cmp_eq_u32 s3, 7
    s_cbranch_scc0 L_sk_45
    s_lshl_b32 s12, s75, 13
    s_and_b32 s13, s4, 7
    s_lshl_b32 s13, s13, 7
    s_add_u32 s12, s12, s13
    s_add_u32 s12, s12, 987136
    v_lshlrev_b32 v5, 10, v1
    v_mov_b32 v6, 1
    s_mov_b64 exec, 0xff
    buffer_atomic_add v6, v5, s[44:47], s12 offen sc1
    s_mov_b64 exec, -1
L_sk_45:
    s_lshl_b32 s79, s75, 20
    s_lshl_b32 s12, s74, 10
    s_add_u32 s79, s79, s12
    s_lshl_b32 s12, s3, 7
    s_add_u32 s79, s79, s12
    s_add_u32 s79, s79, 2097152
    s_add_u32 s84, s79, 524288
    s_mov_b32 s15, 0x07060302
    s_waitcnt lgkmcnt(3)
    v_mfma_f32_16x16x32_bf16 v[84:87], a[64:67], v[64:67], 0
    v_mfma_f32_16x16x32_bf16 v[88:91], a[68:71], v[64:67], 0
    v_mfma_f32_16x16x32_bf16 v[92:95], a[72:75], v[64:67], 0
    v_mfma_f32_16x16x32_bf16 v[96:99], a[76:79], v[64:67], 0
    s_waitcnt lgkmcnt(2)
    v_mfma_f32_16x16x32_bf16 v[84:87], a[80:83], v[68:71], v[84:87]
    v_mfma_f32_16x16x32_bf16 v[88:91], a[84:87], v[68:71], v[88:91]
    v_mfma_f32_16x16x32_bf16 v[92:95], a[88:91], v[68:71], v[92:95]
    v_mfma_f32_16x16x32_bf16 v[96:99], a[92:95], v[68:71], v[96:99]
    s_waitcnt lgkmcnt(1)
    v_mfma_f32_16x16x32_bf16 v[84:87], a[96:99], v[72:75], v[84:87]
    v_mfma_f32_16x16x32_bf16 v[88:91], a[100:103], v[72:75], v[88:91]
    v_mfma_f32_16x16x32_bf16 v[92:95], a[104:107], v[72:75], v[92:95]
    v_mfma_f32_16x16x32_bf16 v[96:99], a[108:111], v[72:75], v[96:99]
    s_waitcnt lgkmcnt(0)
    v_mfma_f32_16x16x32_bf16 v[84:87], a[112:115], v[76:79], v[84:87]
    v_mfma_f32_16x16x32_bf16 v[88:91], a[116:119], v[76:79], v[88:91]
    v_mfma_f32_16x16x32_bf16 v[92:95], a[120:123], v[76:79], v[92:95]
    v_mfma_f32_16x16x32_bf16 v[96:99], a[124:127], v[76:79], v[96:99]
    s_cmp_eq_u32 s3, 4
    s_cbranch_scc0 L_sk_46
    v_mov_b32 v48, 0x3f803f80
    v_mov_b32 v49, 0x3f803f80
    v_mov_b32 v50, 0x3f803f80
    v_mov_b32 v51, 0x3f803f80
    s_nop 1
    v_mfma_f32_16x16x32_bf16 v[100:103], v[48:51], v[64:67], 0
    v_mfma_f32_16x16x32_bf16 v[100:103], v[48:51], v[68:71], v[100:103]
    v_mfma_f32_16x16x32_bf16 v[100:103], v[48:51], v[72:75], v[100:103]
    v_mfma_f32_16x16x32_bf16 v[100:103], v[48:51], v[76:79], v[100:103]
L_sk_46:
    s_cmp_eq_u32 s3, 1
    s_cbranch_scc0 L_sk_47
    s_mov_b64 exec, 255
    v_mov_b32 v9, 0
    buffer_atomic_add v9, v20, s[44:47], s90 offen sc0 sc1
    s_mov_b64 exec, -1
L_sk_47:
    s_nop 0
    v_perm_b32 v84, v85, v84, s15
    v_perm_b32 v85, v87, v86, s15
    ds_write_b64 v34, v[84:85] offset:0
    v_perm_b32 v88, v89, v88, s15
    v_perm_b32 v89, v91, v90, s15
    ds_write_b64 v34, v[88:89] offset:32
    v_perm_b32 v92, v93, v92, s15
    v_perm_b32 v93, v95, v94, s15
    ds_write_b64 v34, v[92:93] offset:64
    v_perm_b32 v96, v97, v96, s15
    v_perm_b32 v97, v99, v98, s15
    ds_write_b64 v34, v[96:97] offset:96
    s_mov_b32 s15, 0xfffefffe
    s_waitcnt lgkmcnt(0)
    ds_read_b128 v[64:67], v35
    ds_read_b128 v[68:71], v35 offset:1152
    s_waitcnt lgkmcnt(1)
    v_and_or_b32 v64, v64, s15, v22
    v_and_or_b32 v65, v65, s15, v23
    v_and_or_b32 v66, v66, s15, v24
    v_and_or_b32 v67, v67, s15, v25
    buffer_store_dwordx4 v[64:67], v36, s[44:47], s79 offen sc1
    s_waitcnt lgkmcnt(0)
    v_and_or_b32 v68, v68, s15, v22
    v_and_or_b32 v69, v69, s15, v23
    v_and_or_b32 v70, v70, s15, v24
    v_and_or_b32 v71, v71, s15, v25
    buffer_store_dwordx4 v[68:71], v36, s[44:47], s84 offen sc1
    s_cmp_eq_u32 s3, 4
    s_cbranch_scc0 L_sk_48
    v_mov_b32 v48, v29
    v_mov_b32 v49, v100
    v_mov_b32 v50, s6
    v_mov_b32 v51, s6
    s_lshl_b32 s12, s75, 8
    s_lshl_b32 s13, s74, 9
    s_add_u32 s12, s12, s13
    s_add_u32 s12, s12, 196608
    s_mov_b64 exec, 0xffff
    buffer_store_dwordx4 v[48:51], v12, s[44:47], s12 offen sc1
    s_mov_b64 exec, -1
L_sk_48:
    s_lshl_b32 s79, s98, 16
    s_lshl_b32 s12, s3, 13
    s_add_u32 s79, s79, s12
    s_lshl_b32 s12, s99, 8
    s_add_u32 s79, s79, s12
    s_add_u32 s79, s79, 2097152
    s_add_u32 s84, s79, 4096
    s_lshl_b32 s74, s98, 4
    s_lshl_b32 s12, s3, 12
    s_add_u32 s74, s74, s12
    s_add_u32 s74, s74, 196608
    s_cmp_eq_u32 s3, 4
    s_cbranch_scc0 L_sk_49
    s_waitcnt vmcnt(3)
L_sk_49:
    s_cmp_lg_u32 s3, 4
    s_cbranch_scc0 L_sk_50
    s_waitcnt vmcnt(2)
L_sk_50:
    s_cmp_eq_u32 s3, 1
    s_cbranch_scc0 L_sk_53
    s_mov_b32 s14, 0
    s_mov_b64 exec, 255
L_hint_51:
    v_cmp_gt_u32 vcc, 8, v9
    s_add_u32 s14, s14, 1
    s_cmp_ge_u32 s14, 40
    s_cbranch_scc1 L_hinted_52
    s_cmp_eq_u64 vcc, 0
    s_cbranch_scc1 L_hinted_52
    v_mov_b32 v9, 0
    buffer_atomic_add v9, v20, s[44:47], s90 offen sc0 sc1
    s_waitcnt vmcnt(0)
    s_branch L_hint_51
L_hinted_52:
    s_mov_b64 exec, -1
L_sk_53:
    s_barrier
    buffer_load_dwordx4 v[84:87], v38, s[44:47], s74 offen sc1
    buffer_load_dwordx4 v[64:67], v37, s[44:47], s79 offen sc1
    buffer_load_dwordx4 v[68:71], v37, s[44:47], s84 offen sc1
    s_cmp_lt_u32 s3, 4
    s_cbranch_scc0 L_sk_56
    v_xor_b32 v5, 32, v8
    ds_read_b64_tr_b16 a[0:1], v8 offset:0
    ds_read_b64_tr_b16 a[16:17], v5 offset:0
    ds_read_b64_tr_b16 a[2:3], v8 offset:4096
    ds_read_b64_tr_b16 a[18:19], v5 offset:4096
    ds_read_b64_tr_b16 a[4:5], v8 offset:8192
    ds_read_b64_tr_b16 a[20:21], v5 offset:8192
    ds_read_b64_tr_b16 a[6:7], v8 offset:12288
    ds_read_b64_tr_b16 a[22:23], v5 offset:12288
    ds_read_b64_tr_b16 a[8:9], v8 offset:16384
    ds_read_b64_tr_b16 a[24:25], v5 offset:16384
    ds_read_b64_tr_b16 a[10:11], v8 offset:20480
    ds_read_b64_tr_b16 a[26:27], v5 offset:20480
    ds_read_b64_tr_b16 a[12:13], v8 offset:24576
    ds_read_b64_tr_b16 a[28:29], v5 offset:24576
    ds_read_b64_tr_b16 a[14:15], v8 offset:28672
    ds_read_b64_tr_b16 a[30:31], v5 offset:28672
L_sk_56:
    s_mov_b32 s15, 0x10000
    s_mov_b32 s13, 0xfffe0000
    v_mov_b32 v6, 0x10000
    s_waitcnt vmcnt(0)
    v_xor_b32 v9, v64, v22
    v_bitop3_b32 v9, v65, v23, v9 bitop3:0xbe
    v_bitop3_b32 v9, v66, v24, v9 bitop3:0xbe
    v_bitop3_b32 v9, v67, v25, v9 bitop3:0xbe
    v_bitop3_b32 v9, v68, v22, v9 bitop3:0xbe
    v_bitop3_b32 v9, v69, v23, v9 bitop3:0xbe
    v_bitop3_b32 v9, v70, v24, v9 bitop3:0xbe
    v_bitop3_b32 v9, v71, v25, v9 bitop3:0xbe
    v_and_b32 v9, 0x10001, v9
    v_bitop3_b32 v9, v86, s6, v9 bitop3:0xbe
    v_cmp_ne_u32 vcc, 0, v9
    s_nop 0
    s_wqm_b64 vcc, vcc
    s_mov_b32 s14, 0
    s_and_b64 exec, exec, vcc
    s_cbranch_scc0 L_got_55
L_poll_54:
    buffer_load_dwordx4 v[84:87], v38, s[44:47], s74 offen sc1
    buffer_load_dwordx4 v[64:67], v37, s[44:47], s79 offen sc1
    buffer_load_dwordx4 v[68:71], v37, s[44:47], s84 offen sc1
    s_waitcnt vmcnt(0)
    v_xor_b32 v9, v64, v22
    v_bitop3_b32 v9, v65, v23, v9 bitop3:0xbe
    v_bitop3_b32 v9, v66, v24, v9 bitop3:0xbe
    v_bitop3_b32 v9, v67, v25, v9 bitop3:0xbe
    v_bitop3_b32 v9, v68, v22, v9 bitop3:0xbe
    v_bitop3_b32 v9, v69, v23, v9 bitop3:0xbe
    v_bitop3_b32 v9, v70, v24, v9 bitop3:0xbe
    v_bitop3_b32 v9, v71, v25, v9 bitop3:0xbe
    v_and_b32 v9, 0x10001, v9
    v_bitop3_b32 v9, v86, s6, v9 bitop3:0xbe
    v_cmp_ne_u32 vcc, 0, v9
    s_nop 0
    s_wqm_b64 vcc, vcc
    s_add_u32 s14, s14, 1
    s_cmp_lt_u32 s14, 262144
    s_cbranch_scc0 L_got_55
    s_and_b64 exec, exec, vcc
    s_cbranch_scc1 L_poll_54
L_got_55:
    s_mov_b64 exec, -1
    v_max_f32_dpp v28, v84, v84 row_ror:8 row_mask:0xf bank_mask:0xf
    v_mov_b32 v5, v28
    v_lshl_or_b32 v48, v64, 16, s15
    v_and_or_b32 v49, v64, s13, v6
    v_permlane16_swap_b32 v28, v5
    v_max_f32 v28, v28, v5
    v_mov_b32 v5, v28
    v_lshl_or_b32 v50, v65, 16, s15
    v_and_or_b32 v51, v65, s13, v6
    v_permlane32_swap_b32 v28, v5
    v_max_f32 v28, v28, v5
    v_sub_f32 v84, v84, v28
    v_exp_f32 v84, v84
    v_lshl_or_b32 v52, v66, 16, s15
    v_and_or_b32 v53, v66, s13, v6
    v_lshl_or_b32 v54, v67, 16, s15
    v_and_or_b32 v55, v67, s13, v6
    v_mul_f32 v29, v84, v85
    v_mov_b32_dpp v88, v84 row_newbcast:8 row_mask:0xf bank_mask:0xf
    v_mov_b32_dpp v84, v84 row_newbcast:0 row_mask:0xf bank_mask:0xf
    v_lshl_or_b32 v56, v68, 16, s15
    v_and_or_b32 v57, v68, s13, v6
    v_lshl_or_b32 v58, v69, 16, s15
    v_and_or_b32 v59, v69, s13, v6
    v_lshl_or_b32 v60, v70, 16, s15
    v_and_or_b32 v61, v70, s13, v6
    v_lshl_or_b32 v62, v71, 16, s15
    v_and_or_b32 v63, v71, s13, v6
    v_add_f32_dpp v29, v29, v29 row_ror:8 row_mask:0xf bank_mask:0xf
    v_mul_f32 v48, v48, v84
    v_mul_f32 v49, v49, v84
    v_mul_f32 v50, v50, v84
    v_mul_f32 v51, v51, v84
    v_mul_f32 v52, v52, v84
    v_mul_f32 v53, v53, v84
    v_mul_f32 v54, v54, v84
    v_mul_f32 v55, v55, v84
    v_fmac_f32 v48, v56, v88
    v_fmac_f32 v49, v57, v88
    v_fmac_f32 v50, v58, v88
    v_fmac_f32 v51, v59, v88
    v_fmac_f32 v52, v60, v88
    v_fmac_f32 v53, v61, v88
    v_fmac_f32 v54, v62, v88
    v_fmac_f32 v55, v63, v88
    v_permlane32_swap_b32 v48, v52
    v_permlane32_swap_b32 v49, v53
    v_permlane32_swap_b32 v50, v54
    v_permlane32_swap_b32 v51, v55
    v_mov_b32 v5, v29
    v_add_f32 v48, v48, v52
    v_add_f32 v49, v49, v53
    v_add_f32 v50, v50, v54
    v_add_f32 v51, v51, v55
    v_permlane16_swap_b32 v29, v5
    v_permlane16_swap_b32 v48, v50
    v_permlane16_swap_b32 v49, v51
    v_add_f32 v29, v29, v5
    v_add_f32 v48, v48, v50
    v_add_f32 v49, v49, v51
    v_mov_b32 v5, v29
    v_cvt_pk_bf16_f32 v48, v48, v49
    ds_write_b32 v39, v48
    v_permlane32_swap_b32 v29, v5
    v_add_f32 v29, v29, v5
    s_mov_b64 exec, 1
    ds_write2_b32 v30, v28, v29 offset0:0 offset1:8
    s_mov_b64 exec, -1
    s_waitcnt lgkmcnt(0)
    s_barrier
    s_cmp_lt_u32 s3, 4
    s_cbranch_scc0 L_sk_57
    ds_read_b128 v[108:111], v41
    ds_read_b128 v[112:115], v42
    ds_read_b128 v[64:67], v40 offset:0
    ds_read_b128 v[68:71], v40 offset:64
    ds_read_b128 v[72:75], v40 offset:128
    ds_read_b128 v[76:79], v40 offset:192
    ds_read_b128 v[116:119], v41 offset:32
    s_lshl_b32 s12, s98, 11
    s_lshl_b32 s13, s99, 9
    s_add_u32 s12, s12, s13
    s_lshl_b32 s13, s3, 7
    s_add_u32 s12, s12, s13
    s_add_u32 s76, s12, 131072
    s_waitcnt lgkmcnt(4)
    v_mfma_f32_16x16x32_bf16 v[84:87], v[64:67], a[0:3], 0
    v_mfma_f32_16x16x32_bf16 v[88:91], v[64:67], a[16:19], 0
    v_max3_f32 v28, v108, v109, v110
    v_max3_f32 v5, v111, v112, v113
    v_max3_f32 v28, v28, v114, v115
    v_max_f32 v28, v28, v5
    s_waitcnt lgkmcnt(3)
    v_mfma_f32_16x16x32_bf16 v[84:87], v[68:71], a[4:7], v[84:87]
    v_mfma_f32_16x16x32_bf16 v[88:91], v[68:71], a[20:23], v[88:91]
    v_sub_f32 v108, v108, v28
    v_sub_f32 v109, v109, v28
    v_sub_f32 v110, v110, v28
    v_sub_f32 v111, v111, v28
    s_waitcnt lgkmcnt(2)
    v_mfma_f32_16x16x32_bf16 v[84:87], v[72:75], a[8:11], v[84:87]
    v_mfma_f32_16x16x32_bf16 v[88:91], v[72:75], a[24:27], v[88:91]
    v_exp_f32 v108, v108
    v_exp_f32 v109, v109
    v_exp_f32 v110, v110
    v_exp_f32 v111, v111
    s_waitcnt lgkmcnt(1)
    v_mfma_f32_16x16x32_bf16 v[84:87], v[76:79], a[12:15], v[84:87]
    v_mfma_f32_16x16x32_bf16 v[88:91], v[76:79], a[28:31], v[88:91]
    s_waitcnt lgkmcnt(0)
    v_mul_f32 v29, v108, v116
    v_fmac_f32 v29, v109, v117
    v_fmac_f32 v29, v110, v118
    v_fmac_f32 v29, v111, v119
    v_mov_b32 v5, v29
    s_nop 1
    v_permlane16_swap_b32 v29, v5
    v_add_f32 v29, v29, v5
    v_rcp_f32 v29, v29
    v_mul_f32 v84, v84, v108
    v_fmac_f32 v84, v85, v109
    v_fmac_f32 v84, v86, v110
    v_fmac_f32 v84, v87, v111
    v_mul_f32 v88, v88, v108
    v_fmac_f32 v88, v89, v109
    v_fmac_f32 v88, v90, v110
    v_fmac_f32 v88, v91, v111
    s_nop 1
    v_permlane16_swap_b32 v84, v88
    v_add_f32 v84, v84, v88
    v_mul_f32 v84, v84, v29
    v_and_or_b32 v84, v84, s7, v10
    s_mov_b32 exec_hi, 0
    s_add_u32 s15, s76, 196608
    buffer_store_dword v84, v11, s[44:47], s15 offen
    buffer_store_dword v84, v11, s[44:47], s76 offen sc1
    s_mov_b64 exec, -1
L_sk_57:
    s_lshr_b32 s12, s5, 1
    s_lshl_b32 s12, s12, 3
    s_add_u32 s12, s12, s4
    s_cmp_ge_u32 s12, 18
    s_cbranch_scc1 L_Pend
    s_lshl_b32 s74, s12, 1
    s_and_b32 s75, s5, 1
    s_add_u32 s74, s74, s75
    s_mov_b32 s64, s36
    s_mov_b32 s65, s37
    s_mov_b32 s66, 1152
    s_mov_b32 s67, 0x20000
    v_lshrrev_b32 v5, 2, v1
    v_mul_u32_u24 v5, 2304, v5
    v_and_b32 v6, 3, v1
    v_lshl_add_u32 v13, v6, 4, v5
    s_mul_i32 s79, s3, 16*2304
    s_lshl_b32 s12, s74, 6
    s_add_u32 s79, s79, s12
    s_add_u32 s79, s79, 393216
    v_lshlrev_b32 v14, 1, v2
    s_lshl_b32 s75, s74, 5
    buffer_load_ushort v26, v14, s[48:51], s75 offen
    v_lshrrev_b32 v5, 5, v1
    v_lshl_add_u32 v6, v6, 1, v5
    v_bfe_u32 v5, v1, 4, 1
    v_lshl_add_u32 v6, v6, 1, v5
    s_lshl_b32 s12, s3, 2
    s_add_u32 s12, s12, 159424
    v_lshl_add_u32 v6, v6, 5, s12
    v_lshlrev_b32 v5, 5, v2
    v_add_u32 v5, 159424, v5
    s_mov_b32 s84, 0x000f000f
    s_mov_b32 s85, 0x000f000f
    s_cmp_eq_u32 s3, 0
    s_cbranch_scc0 L_sk_60
    s_mov_b32 s14, 0
    s_mov_b64 exec, 255
L_hint_58:
    v_mov_b32 v9, 0
    buffer_atomic_add v9, v20, s[44:47], s91 offen sc0 sc1
    s_waitcnt vmcnt(0)
    v_cmp_gt_u32 vcc, 8, v9
    s_add_u32 s14, s14, 1
    s_cmp_ge_u32 s14, 40
    s_cbranch_scc1 L_hinted_59
    s_cmp_lg_u64 vcc, 0
    s_cbranch_scc1 L_hint_58
L_hinted_59:
    s_mov_b64 exec, -1
L_sk_60:
    s_barrier
    buffer_load_dwordx4 v[48:51], v13, s[44:47], s79 offen sc1
    s_waitcnt vmcnt(0)
    v_xor_b32 v9, s8, v48
    v_bitop3_b32 v9, v49, s9, v9 bitop3:0xbe
    v_bitop3_b32 v9, v50, s10, v9 bitop3:0xbe
    v_bitop3_b32 v9, v51, s11, v9 bitop3:0xbe
    v_and_b32 v9, 0xff, v9
    v_cmp_ne_u32 vcc, 0, v9
    s_mov_b32 s14, 0
    s_and_b64 exec, exec, vcc
    s_cbranch_scc0 L_got_62
L_poll_61:
    buffer_load_dwordx4 v[48:51], v13, s[44:47], s79 offen sc1
    s_waitcnt vmcnt(0)
    v_xor_b32 v9, s8, v48
    v_bitop3_b32 v9, v49, s9, v9 bitop3:0xbe
    v_bitop3_b32 v9, v50, s10, v9 bitop3:0xbe
    v_bitop3_b32 v9, v51, s11, v9 bitop3:0xbe
    v_and_b32 v9, 0xff, v9
    v_cmp_ne_u32 vcc, 0, v9
    s_add_u32 s14, s14, 1
    s_cmp_lt_u32 s14, 262144
    s_cbranch_scc0 L_got_62
    s_and_b64 exec, exec, vcc
    s_cbranch_scc1 L_poll_61
L_got_62:
    s_mov_b64 exec, -1
    v_and_b32 v48, s7, v48
    v_and_b32 v49, s7, v49
    v_and_b32 v50, s7, v50
    v_and_b32 v51, s7, v51
    s_nop 0
    v_permlane32_swap_b32 v48, v50
    v_permlane32_swap_b32 v49, v51
    v_add_f32 v48, v48, v50
    v_add_f32 v49, v49, v51
    s_nop 1
    v_permlane16_swap_b32 v48, v49
    v_add_f32 v48, v48, v49
    s_nop 1
    v_add_f32_dpp v48, v48, v48 row_ror:8 row_mask:0xf bank_mask:0xf
    s_nop 1
    v_add_f32_dpp v48, v48, v48 row_ror:4 row_mask:0xf bank_mask:0xf
    s_mov_b64 exec, s[84:85]
    ds_write_b32 v6, v48
    s_mov_b64 exec, -1
    s_waitcnt lgkmcnt(0)
    s_barrier
    s_lshl_b32 s12, s74, 3
    s_add_u32 s12, s12, s3
    s_cmp_eq_u32 s12, 1
    s_cbranch_scc0 L_sk_63
    s_mov_b64 exec, 1
    v_mov_b32 v5, s6
    buffer_store_dword v5, v11, s[44:47], 0 offen
L_sk_63:
    s_cmp_lg_u32 s3, 0
    s_cbranch_scc1 L_Pend
    ds_read_b128 v[48:51], v5
    ds_read_b128 v[52:55], v5 offset:16
    v_lshlrev_b32 v26, 16, v26
    s_waitcnt lgkmcnt(0)
    v_add_f32 v48, v48, v52
    v_add_f32 v49, v49, v53
    v_add_f32 v50, v50, v54
    v_add_f32 v51, v51, v55
    v_add_f32 v48, v48, v50
    v_add_f32 v49, v49, v51
    v_add_f32 v48, v48, v49
    v_add_f32 v48, v48, v26
    v_cvt_pk_bf16_f32 v48, v48, v48
    s_mov_b64 exec, 0xffff
    buffer_store_short v48, v14, s[64:67], s75 offen
L_Pend:
L_exit:
    s_endpgm
L_P1:
.section .rodata,"a"
.p2align 6
.amdhsa_kernel parallel_sum__compressed_kv_cla__glu_gated_glu__decode_kernel
  .amdhsa_next_free_vgpr 256
  .amdhsa_next_free_sgpr 102
  .amdhsa_accum_offset 128
  .amdhsa_group_segment_fixed_size 0
  .amdhsa_kernarg_size 104
  .amdhsa_user_sgpr_count 2
  .amdhsa_user_sgpr_kernarg_segment_ptr 1
  .amdhsa_system_sgpr_workgroup_id_x 1
  .amdhsa_float_denorm_mode_32 3
.end_amdhsa_kernel
```
